```python
import torch

def _softmax(x, axis=-1):
    return torch.softmax(x, dim=axis)
def _gelu(x):
    return torch.nn.functional.gelu(x, approximate="tanh")
def _silu(x):
    return torch.nn.functional.silu(x)
def _sigmoid(x):
    return torch.sigmoid(x)
def _layernorm(x, axis=-1, eps=1e-5):
    m = x.mean(dim=axis, keepdim=True)
    v = x.var(dim=axis, keepdim=True, unbiased=False)
    return (x - m) / torch.sqrt(v + eps)
def _scatter_add(tgt, idx, src, axis=0):
    return tgt.clone().index_add_(axis, idx, src)
def _segment_sum(src, seg, n):
    out = torch.zeros((n,) + src.shape[1:], dtype=src.dtype)
    return out.index_add_(0, seg, src)
def _pad(x, pw):
    flat = tuple(v for pair in reversed(pw) for v in pair)
    return torch.nn.functional.pad(x, flat)

kernel_name = 'standalone__dcn_v2_cross__recsys'

def setup_inputs():

    _w = (lambda a: (lambda t: t.to(torch.bfloat16) if t.is_floating_point() else t)(torch.as_tensor(a)))
    B, F, D, L = 16384, 100, 64, 3
    Din = min(F * D, 1024)
    return {
        "x0": _w((lambda *s: torch.randn(*s, dtype=torch.bfloat16) * 0.05)(B, Din)),
        "ws": _w((lambda *s: torch.randn(*s, dtype=torch.bfloat16) * 0.05)(L, Din, Din)),
        "bs": _w((lambda *s: torch.randn(*s, dtype=torch.bfloat16) * 0.05)(L, Din)),
    }

def reference(x0, ws, bs):
    x = x0
    for l in range(ws.shape[0]):
        x = x0 * (x @ ws[l] + bs[l]) + x
    return x
```

```asm
; @launch grid=(256,1,1) block=(256,1,1) lds=163840
.amdgcn_target "amdgcn-amd-amdhsa--gfx950"
.text
.globl standalone__dcn_v2_cross__recsys_kernel
.p2align 8
.type standalone__dcn_v2_cross__recsys_kernel,@function
standalone__dcn_v2_cross__recsys_kernel:
s_cmp_lt_u32 s2, 256
s_cbranch_scc1 L_go
s_endpgm
L_go:
s_load_dwordx2 s[12:13], s[0:1], 0
s_load_dwordx2 s[8:9], s[0:1], 8
s_load_dwordx2 s[24:25], s[0:1], 16
s_load_dwordx2 s[20:21], s[0:1], 24
s_load_dwordx2 s[16:17], s[0:1], 40
s_getpc_b64 s[80:81]
L_pc:
v_lshrrev_b32 v47, 6, v0
s_lshr_b32 s3, s2, 3
v_readfirstlane_b32 s55, v47
v_lshrrev_b32 v16, 4, v0
v_lshl_add_u32 v16, s3, 4, v16
v_lshlrev_b32 v16, 7, v16
v_min_u32 v31, L_codeend-L_pc-4, v16
global_load_dword v10, v31, s[80:81]
s_and_b32 s56, s2, 7
s_lshr_b32 s72, s2, 5
s_lshl3_add_u32 s56, s56, s72
v_bfe_u32 v48, v0, 3, 3
v_and_b32 v49, 7, v0
v_bfe_u32 v42, v0, 4, 2
v_xor_b32 v47, v49, v42
v_lshlrev_b32 v47, 4, v47
v_lshl_add_u32 v47, v48, 11, v47
s_lshl2_add_u32 s53, s56, s55
s_lshl_b32 s53, s53, 17
v_add_u32 v7, s53, v47
v_xor_b32 v8, 64, v7
v_add_u32 v8, 15360, v8
s_lshl_b32 s36, s55, 13
s_mov_b32 s14, 33554432
s_mov_b32 s15, 0x20000
s_and_b32 s54, s3, 3
s_mov_b32 s33, 30720
s_mov_b32 s34, 65536
s_mov_b32 s35, 96256
v_bfe_u32 v43, v0, 2, 2
s_lshl_b32 s67, s72, 15
s_add_u32 s67, s67, s36
s_lshl_b32 s69, s54, 9
s_add_u32 s67, s67, s69
v_lshlrev_b32 v46, 7, v43
v_lshl_add_u32 v46, v42, 11, v46
s_mov_b32 s10, 6291456
s_mov_b32 s11, 0x20000
s_mov_b32 m0, s36
s_waitcnt lgkmcnt(0)
buffer_load_dwordx4 v7, s[12:15], 0 offen nt lds
buffer_load_dwordx4 v8, s[12:15], 0 offen offset:1024 nt lds
buffer_load_dwordx4 v7, s[12:15], s33 offen offset:2048 nt lds
buffer_load_dwordx4 v8, s[12:15], s33 offen offset:3072 nt lds
s_add_u32 m0, s36, 0x1000
s_nop 0
buffer_load_dwordx4 v7, s[12:15], s34 offen nt lds
buffer_load_dwordx4 v8, s[12:15], s34 offen offset:1024 nt lds
buffer_load_dwordx4 v7, s[12:15], s35 offen offset:2048 nt lds
buffer_load_dwordx4 v8, s[12:15], s35 offen offset:3072 nt lds
buffer_load_dword v10, v46, s[8:11], s67 offen
s_mov_b32 s26, 6144
s_mov_b32 s27, 0x20000
buffer_load_dword v10, v46, s[24:27], s69 offen
s_lshl_b32 s66, s56, 7
s_add_u32 s66, s66, 0x4010000
s_load_dword s49, s[16:17], s66
v_and_b32 v40, 63, v0
v_and_b32 v41, 15, v0
v_and_b32 v44, 3, v0
v_and_b32 v45, 1, v42
s_add_u32 s37, s36, 0x10000
s_add_u32 s38, s36, 0x20000
s_add_u32 s39, s36, 0x8000
s_add_u32 s40, s36, 0x18000
v_lshlrev_b32 v0, 4, v40
s_lshr_b32 s70, s55, 1
s_and_b32 s71, s55, 1
s_mov_b32 s29, 30720
s_mov_b32 s30, 8192
s_mov_b32 s31, 38912
s_lshl_b32 s61, s71, 6
s_add_u32 s53, s69, s61
v_lshlrev_b32 v47, 3, v42
v_add_u32 v12, s53, v47
v_bfe_u32 v47, v40, 1, 2
v_lshl_add_u32 v12, v47, 7, v12
v_and_b32 v47, 1, v40
v_lshl_add_u32 v12, v47, 5, v12
s_lshl_b32 s53, s70, 8
s_add_u32 s53, s53, s69
s_lshl_b32 s51, s71, 16
s_add_u32 s53, s53, s51
v_lshlrev_b32 v47, 4, v44
v_lshl_add_u32 v47, v42, 6, v47
v_lshl_add_u32 v47, v43, 11, v47
v_add_u32 v5, s53, v47
v_xor_b32 v6, 32, v5
v_add_u32 v6, 15360, v6
s_mov_b32 s22, 33554432
s_mov_b32 s23, 0x20000
s_mov_b32 s18, 0x10000000
s_mov_b32 s19, 0x20000
s_lshl_b32 s47, s56, 9
s_add_u32 s47, s47, 0x4000000
v_lshrrev_b32 v47, 1, v41
v_xor_b32 v47, v42, v47
v_lshlrev_b32 v47, 4, v47
v_lshl_add_u32 v47, v41, 7, v47
s_lshl_b32 s78, s70, 14
v_add_u32 v1, s78, v47
v_xor_b32 v2, 64, v1
v_lshlrev_b32 v47, 10, v42
v_lshl_add_u32 v47, v43, 6, v47
v_lshl_add_u32 v47, v45, 5, v47
v_lshl_add_u32 v47, v44, 3, v47
s_lshl_b32 s53, s71, 8
s_add_u32 s53, s53, 32768
v_add_u32 v3, s53, v47
v_xor_b32 v4, 32, v3
v_and_b32 v48, 1, v41
v_lshlrev_b32 v48, 4, v48
v_mov_b32 v49, 0x3f80
v_lshlrev_b32 v48, v48, v49
v_lshlrev_b32 v49, 3, v42
v_sub_u32 v49, v41, v49
v_ashrrev_i32 v49, 1, v49
v_cmp_eq_u32 vcc, 0, v49
s_mov_b32 s62, 0x20000
s_mov_b32 s63, 0x28000
v_cndmask_b32 v47, 0, v48, vcc
v_accvgpr_write_b32 a208, v47
v_cmp_eq_u32 vcc, 1, v49
s_mov_b32 s64, 0x30000
s_mov_b32 s65, 0xffff0000
v_cndmask_b32 v47, 0, v48, vcc
v_accvgpr_write_b32 a209, v47
v_cmp_eq_u32 vcc, 2, v49
s_mov_b32 s45, 0
s_mov_b32 s41, 1
v_cndmask_b32 v47, 0, v48, vcc
v_accvgpr_write_b32 a210, v47
v_cmp_eq_u32 vcc, 3, v49
s_mov_b32 s101, 0x38000
s_lshl_b32 s48, s54, 7
v_cndmask_b32 v47, 0, v48, vcc
v_accvgpr_write_b32 a211, v47
v_cmp_eq_u32 vcc, -8, v49
s_add_u32 s48, s48, s47
s_mul_i32 s60, s71, 7168
v_cndmask_b32 v47, 0, v48, vcc
v_accvgpr_write_b32 a212, v47
v_cmp_eq_u32 vcc, -7, v49
s_mov_b32 s59, 8192
s_mov_b32 s58, 0
v_cndmask_b32 v47, 0, v48, vcc
v_accvgpr_write_b32 a213, v47
v_cmp_eq_u32 vcc, -6, v49
s_mov_b32 s68, s54
s_mov_b32 s57, 1
v_cndmask_b32 v47, 0, v48, vcc
v_accvgpr_write_b32 a214, v47
v_cmp_eq_u32 vcc, -5, v49
s_mov_b32 s44, 0
s_mov_b32 s91, 15
v_cndmask_b32 v47, 0, v48, vcc
v_accvgpr_write_b32 a215, v47
s_cmp_ge_u32 0, s54
s_cselect_b32 s96, 4, 0
s_cmp_ge_u32 1, s54
s_cselect_b32 s97, 8, 4
s_cmp_ge_u32 2, s54
s_cselect_b32 s98, 12, 8
s_mul_i32 s53, s71, 114688
s_sub_u32 s53, s69, s53
v_xor_b32 v15, s61, v7
v_add_u32 v15, s53, v15
s_mov_b32 s3, 1920
s_lshl2_add_u32 s53, s2, s55
s_lshl_b32 s53, s53, 12
s_add_u32 s53, s53, 0x200000
v_min_u32 v9, 2, v42
v_lshlrev_b32 v9, 7, v9
s_mov_b32 s69, 2048
s_mov_b32 s67, 0x100000
buffer_load_dwordx2 v[38:39], v12, s[24:27], 0 offen
s_mov_b32 m0, s39
s_nop 0
buffer_load_dwordx4 v5, s[8:11], 0 offen lds
buffer_load_dwordx4 v6, s[8:11], 0 offen offset:1024 lds
buffer_load_dwordx4 v5, s[8:11], s29 offen offset:2048 lds
buffer_load_dwordx4 v6, s[8:11], s29 offen offset:3072 lds
s_add_u32 m0, s39, 0x1000
s_nop 0
buffer_load_dwordx4 v5, s[8:11], s30 offen lds
buffer_load_dwordx4 v6, s[8:11], s30 offen offset:1024 lds
buffer_load_dwordx4 v5, s[8:11], s31 offen offset:2048 lds
buffer_load_dwordx4 v6, s[8:11], s31 offen offset:3072 lds
s_mov_b64 exec, 0
s_cmp_eq_u32 s55, 1
s_cbranch_scc1 HOP1
s_cmp_eq_u32 s55, 2
s_cbranch_scc1 HOP2
s_cmp_eq_u32 s55, 3
s_cbranch_scc1 HOP3
s_branch HOP0
HOPEND:
s_mov_b64 exec, -1
s_waitcnt vmcnt(8)
v_mov_b32_dpp v69, v38 row_newbcast:0 row_mask:0xf bank_mask:0xf
v_mov_b32_dpp v71, v39 row_newbcast:0 row_mask:0xf bank_mask:0xf
v_lshlrev_b32 v68, 16, v69
v_and_b32 v69, s65, v69
v_lshlrev_b32 v70, 16, v71
v_and_b32 v71, s65, v71
v_add_f32 v68, 1.0, v68
v_add_f32 v69, 1.0, v69
v_add_f32 v70, 1.0, v70
v_add_f32 v71, 1.0, v71
v_mov_b32_dpp v101, v38 row_newbcast:1 row_mask:0xf bank_mask:0xf
v_mov_b32_dpp v103, v39 row_newbcast:1 row_mask:0xf bank_mask:0xf
v_lshlrev_b32 v100, 16, v101
v_and_b32 v101, s65, v101
v_lshlrev_b32 v102, 16, v103
v_and_b32 v103, s65, v103
v_add_f32 v100, 1.0, v100
v_add_f32 v101, 1.0, v101
v_add_f32 v102, 1.0, v102
v_add_f32 v103, 1.0, v103
v_mov_b32_dpp v133, v38 row_newbcast:2 row_mask:0xf bank_mask:0xf
v_mov_b32_dpp v135, v39 row_newbcast:2 row_mask:0xf bank_mask:0xf
v_lshlrev_b32 v132, 16, v133
v_and_b32 v133, s65, v133
v_lshlrev_b32 v134, 16, v135
v_and_b32 v135, s65, v135
v_add_f32 v132, 1.0, v132
v_add_f32 v133, 1.0, v133
v_add_f32 v134, 1.0, v134
v_add_f32 v135, 1.0, v135
v_mov_b32_dpp v165, v38 row_newbcast:3 row_mask:0xf bank_mask:0xf
v_mov_b32_dpp v167, v39 row_newbcast:3 row_mask:0xf bank_mask:0xf
v_lshlrev_b32 v164, 16, v165
v_and_b32 v165, s65, v165
v_lshlrev_b32 v166, 16, v167
v_and_b32 v167, s65, v167
v_add_f32 v164, 1.0, v164
v_add_f32 v165, 1.0, v165
v_add_f32 v166, 1.0, v166
v_add_f32 v167, 1.0, v167
s_branch L_main
SLOW_S2:
buffer_load_dword v10, off, s[16:19], s53 sc1
s_waitcnt vmcnt(0)
v_readfirstlane_b32 s72, v10
s_cmp_eq_u32 s67, 0
s_cbranch_scc1 BACK_S2
s_sub_u32 s67, s67, 1
s_sub_u32 s72, s72, s73
s_cmp_gt_u32 s72, 7
s_cbranch_scc0 BACK_S2
s_sleep 1
s_branch SLOW_S2
SLOW_S3:
buffer_load_dword v10, off, s[16:19], s53 sc1
s_waitcnt vmcnt(0)
v_readfirstlane_b32 s72, v10
s_cmp_eq_u32 s67, 0
s_cbranch_scc1 BACK_S3
s_sub_u32 s67, s67, 1
s_sub_u32 s72, s72, s73
s_cmp_gt_u32 s72, 7
s_cbranch_scc0 BACK_S3
s_sleep 1
s_branch SLOW_S3
SLOW_S4:
buffer_load_dword v10, off, s[16:19], s53 sc1
s_waitcnt vmcnt(0)
v_readfirstlane_b32 s72, v10
s_cmp_eq_u32 s67, 0
s_cbranch_scc1 BACK_S4
s_sub_u32 s67, s67, 1
s_sub_u32 s72, s72, s73
s_cmp_gt_u32 s72, 7
s_cbranch_scc0 BACK_S4
s_sleep 1
s_branch SLOW_S4
SLOW_G1:
buffer_load_dword v10, off, s[16:19], s53 sc1
s_waitcnt vmcnt(0)
v_readfirstlane_b32 s72, v10
s_cmp_eq_u32 s67, 0
s_cbranch_scc1 BACK_G1
s_sub_u32 s67, s67, 1
s_sub_u32 s72, s72, s73
s_cmp_gt_u32 s72, 7
s_cbranch_scc0 BACK_G1
s_sleep 1
s_branch SLOW_G1
SLOW_A13:
buffer_load_dword v10, off, s[16:19], s53 sc1
s_waitcnt vmcnt(0)
v_readfirstlane_b32 s72, v10
s_cmp_eq_u32 s67, 0
s_cbranch_scc1 BACK_A13
s_sub_u32 s67, s67, 1
s_sub_u32 s72, s72, s73
s_cmp_gt_u32 s72, 7
s_cbranch_scc0 BACK_A13
s_sleep 1
s_branch SLOW_A13
.p2align 12
.fill 768, 4, 0xbf800000
L_main:
HOP0:
s_cbranch_execz HOP4
s_waitcnt vmcnt(0) lgkmcnt(0)
s_barrier
ds_read_b64_tr_b16 a[64:65], v3 offset:0
ds_read_b64_tr_b16 a[66:67], v3 offset:4096
ds_read_b128 a[0:3], v1 offset:0
ds_read_b64_tr_b16 a[68:69], v3 offset:8192
ds_read_b64_tr_b16 a[70:71], v3 offset:12288
ds_read_b128 a[4:7], v2 offset:0
ds_read_b128 a[12:15], v2 offset:2048
ds_read_b128 a[8:11], v1 offset:2048
ds_read_b128 a[16:19], v1 offset:4096
ds_read_b128 a[20:23], v2 offset:4096
ds_read_b128 a[28:31], v2 offset:6144
ds_read_b128 a[24:27], v1 offset:6144
ds_read_b128 a[32:35], v1 offset:8192
ds_read_b128 a[36:39], v2 offset:8192
s_waitcnt lgkmcnt(8)
v_mfma_f32_16x16x32_bf16 v[40:43], a[64:67], a[0:3], v[68:71]
s_lshl_b32 s70, s41, 17
s_add_u32 s70, s70, s45
ds_read_b128 a[44:47], v2 offset:10240
v_mfma_f32_16x16x32_bf16 v[40:43], a[68:71], a[4:7], v[40:43]
s_waitcnt lgkmcnt(7)
s_sub_u32 s71, s70, s44
ds_read_b128 a[40:43], v1 offset:10240
v_mfma_f32_16x16x32_bf16 v[44:47], a[68:71], a[12:15], v[68:71]
s_mov_b32 s44, s70
ds_read_b128 a[48:51], v1 offset:12288
v_add_u32 v5, s71, v5
v_mfma_f32_16x16x32_bf16 v[44:47], a[64:67], a[8:11], v[44:47]
s_waitcnt lgkmcnt(7)
ds_read_b128 a[52:55], v2 offset:12288
v_add_u32 v6, s71, v6
v_mfma_f32_16x16x32_bf16 v[48:51], a[64:67], a[16:19], v[68:71]
s_mov_b32 m0, s40
ds_read_b128 a[60:63], v2 offset:14336
ds_read_b64_tr_b16 a[72:73], v4 offset:0
v_mfma_f32_16x16x32_bf16 v[48:51], a[68:71], a[20:23], v[48:51]
s_waitcnt lgkmcnt(8)
ds_read_b128 a[56:59], v1 offset:14336
ds_read_b64_tr_b16 a[74:75], v4 offset:4096
v_mfma_f32_16x16x32_bf16 v[52:55], a[68:71], a[28:31], v[68:71]
ds_read_b64_tr_b16 a[76:77], v4 offset:8192
v_add_u32 v7, 128, v7
v_mfma_f32_16x16x32_bf16 v[52:55], a[64:67], a[24:27], v[52:55]
s_waitcnt lgkmcnt(9)
ds_read_b64_tr_b16 a[78:79], v4 offset:12288
v_add_u32 v8, 128, v8
v_mfma_f32_16x16x32_bf16 v[56:59], a[64:67], a[32:35], v[68:71]
buffer_load_dwordx4 v5, s[8:11], 0 offen lds
v_mfma_f32_16x16x32_bf16 v[56:59], a[68:71], a[36:39], v[56:59]
s_waitcnt lgkmcnt(8)
v_xor_b32 v36, s61, v1
v_mov_b32_dpp v197, v38 row_newbcast:4 row_mask:0xf bank_mask:0xf
v_mfma_f32_16x16x32_bf16 v[60:63], a[68:71], a[44:47], v[68:71]
buffer_load_dwordx4 v6, s[8:11], 0 offen offset:1024 lds
v_mfma_f32_16x16x32_bf16 v[60:63], a[64:67], a[40:43], v[60:63]
s_waitcnt lgkmcnt(6)
s_sub_u32 s79, s37, s36
v_add_u32 v1, s79, v1
v_mfma_f32_16x16x32_bf16 v[64:67], a[64:67], a[48:51], v[68:71]
buffer_load_dwordx4 v5, s[8:11], s29 offen offset:2048 lds
v_mfma_f32_16x16x32_bf16 v[64:67], a[68:71], a[52:55], v[64:67]
s_waitcnt lgkmcnt(3)
s_sub_u32 s4, s40, s39
v_add_u32 v2, s79, v2
v_mfma_f32_16x16x32_bf16 v[68:71], a[68:71], a[60:63], v[68:71]
v_mov_b32_dpp v199, v39 row_newbcast:4 row_mask:0xf bank_mask:0xf
v_lshlrev_b32 v196, 16, v197
v_mfma_f32_16x16x32_bf16 v[68:71], a[64:67], a[56:59], v[68:71]
s_waitcnt lgkmcnt(0)
v_and_b32 v197, s65, v197
v_lshlrev_b32 v198, 16, v199
v_mfma_f32_16x16x32_bf16 v[72:75], a[72:75], a[0:3], v[100:103]
ds_read_b64_tr_b16 a[64:65], v3 offset:512
v_and_b32 v199, s65, v199
v_mfma_f32_16x16x32_bf16 v[72:75], a[76:79], a[4:7], v[72:75]
buffer_load_dwordx4 v6, s[8:11], s29 offen offset:3072 lds
v_mfma_f32_16x16x32_bf16 v[76:79], a[76:79], a[12:15], v[100:103]
s_add_u32 m0, s40, 0x1000
ds_read_b64_tr_b16 a[66:67], v3 offset:4608
v_add_f32 v196, 1.0, v196
v_mfma_f32_16x16x32_bf16 v[76:79], a[72:75], a[8:11], v[76:79]
v_add_f32 v197, 1.0, v197
v_add_f32 v198, 1.0, v198
v_mfma_f32_16x16x32_bf16 v[80:83], a[72:75], a[16:19], v[100:103]
ds_read_b64_tr_b16 a[68:69], v3 offset:8704
v_add_f32 v199, 1.0, v199
v_mfma_f32_16x16x32_bf16 v[80:83], a[76:79], a[20:23], v[80:83]
buffer_load_dwordx4 v5, s[8:11], s30 offen lds
v_mfma_f32_16x16x32_bf16 v[84:87], a[76:79], a[28:31], v[100:103]
ds_read_b64_tr_b16 a[70:71], v3 offset:12800
v_mov_b32_dpp v229, v38 row_newbcast:5 row_mask:0xf bank_mask:0xf
v_mfma_f32_16x16x32_bf16 v[84:87], a[72:75], a[24:27], v[84:87]
v_mov_b32_dpp v231, v39 row_newbcast:5 row_mask:0xf bank_mask:0xf
v_lshlrev_b32 v228, 16, v229
v_mfma_f32_16x16x32_bf16 v[88:91], a[72:75], a[32:35], v[100:103]
buffer_load_dwordx4 v6, s[8:11], s30 offen offset:1024 lds
v_mfma_f32_16x16x32_bf16 v[88:91], a[76:79], a[36:39], v[88:91]
v_and_b32 v229, s65, v229
v_lshlrev_b32 v230, 16, v231
v_mfma_f32_16x16x32_bf16 v[92:95], a[76:79], a[44:47], v[100:103]
v_and_b32 v231, s65, v231
v_add_f32 v228, 1.0, v228
v_mfma_f32_16x16x32_bf16 v[92:95], a[72:75], a[40:43], v[92:95]
v_add_f32 v229, 1.0, v229
v_add_f32 v230, 1.0, v230
v_mfma_f32_16x16x32_bf16 v[96:99], a[72:75], a[48:51], v[100:103]
buffer_load_dwordx4 v5, s[8:11], s31 offen offset:2048 lds
v_mfma_f32_16x16x32_bf16 v[96:99], a[76:79], a[52:55], v[96:99]
v_add_f32 v231, 1.0, v231
v_mov_b32_dpp v253, v38 row_newbcast:6 row_mask:0xf bank_mask:0xf
v_mfma_f32_16x16x32_bf16 v[100:103], a[76:79], a[60:63], v[100:103]
v_mov_b32_dpp v255, v39 row_newbcast:6 row_mask:0xf bank_mask:0xf
v_lshlrev_b32 v252, 16, v253
v_mfma_f32_16x16x32_bf16 v[100:103], a[72:75], a[56:59], v[100:103]
s_waitcnt lgkmcnt(0)
v_and_b32 v253, s65, v253
v_lshlrev_b32 v254, 16, v255
v_mfma_f32_16x16x32_bf16 v[104:107], a[64:67], a[0:3], v[132:135]
ds_read_b64_tr_b16 a[72:73], v4 offset:512
v_and_b32 v255, s65, v255
v_mfma_f32_16x16x32_bf16 v[104:107], a[68:71], a[4:7], v[104:107]
buffer_load_dwordx4 v6, s[8:11], s31 offen offset:3072 lds
v_mfma_f32_16x16x32_bf16 v[108:111], a[68:71], a[12:15], v[132:135]
ds_read_b64_tr_b16 a[74:75], v4 offset:4608
v_add_f32 v252, 1.0, v252
v_mfma_f32_16x16x32_bf16 v[108:111], a[64:67], a[8:11], v[108:111]
s_mov_b32 m0, s37
v_add_f32 v253, 1.0, v253
v_add_f32 v254, 1.0, v254
v_mfma_f32_16x16x32_bf16 v[112:115], a[64:67], a[16:19], v[132:135]
ds_read_b64_tr_b16 a[76:77], v4 offset:8704
v_add_f32 v255, 1.0, v255
v_mfma_f32_16x16x32_bf16 v[112:115], a[68:71], a[20:23], v[112:115]
buffer_load_dwordx4 v7, s[12:15], 0 offen nt lds
v_mfma_f32_16x16x32_bf16 v[116:119], a[68:71], a[28:31], v[132:135]
ds_read_b64_tr_b16 a[78:79], v4 offset:12800
v_accvgpr_write_b32 a216, v252
v_mfma_f32_16x16x32_bf16 v[116:119], a[64:67], a[24:27], v[116:119]
v_accvgpr_write_b32 a217, v253
v_accvgpr_write_b32 a218, v254
v_mfma_f32_16x16x32_bf16 v[120:123], a[64:67], a[32:35], v[132:135]
v_accvgpr_write_b32 a219, v255
v_accvgpr_write_b32 a220, v252
v_mfma_f32_16x16x32_bf16 v[120:123], a[68:71], a[36:39], v[120:123]
buffer_load_dwordx4 v8, s[12:15], 0 offen offset:1024 nt lds
v_mfma_f32_16x16x32_bf16 v[124:127], a[68:71], a[44:47], v[132:135]
v_accvgpr_write_b32 a221, v253
v_accvgpr_write_b32 a222, v254
v_mfma_f32_16x16x32_bf16 v[124:127], a[64:67], a[40:43], v[124:127]
v_accvgpr_write_b32 a223, v255
v_accvgpr_write_b32 a224, 1.0
v_mfma_f32_16x16x32_bf16 v[128:131], a[64:67], a[48:51], v[132:135]
v_accvgpr_write_b32 a225, 1.0
v_accvgpr_write_b32 a226, 1.0
v_mfma_f32_16x16x32_bf16 v[128:131], a[68:71], a[52:55], v[128:131]
HOP1:
s_cbranch_execz HOP5
buffer_load_dwordx4 v7, s[12:15], s33 offen offset:2048 nt lds
v_mfma_f32_16x16x32_bf16 v[132:135], a[68:71], a[60:63], v[132:135]
v_accvgpr_write_b32 a227, 1.0
v_accvgpr_write_b32 a228, 1.0
v_mfma_f32_16x16x32_bf16 v[132:135], a[64:67], a[56:59], v[132:135]
s_waitcnt lgkmcnt(0)
v_accvgpr_write_b32 a229, 1.0
v_accvgpr_write_b32 a230, 1.0
v_mfma_f32_16x16x32_bf16 v[136:139], a[72:75], a[0:3], v[164:167]
ds_read_b64_tr_b16 a[64:65], v3 offset:16384
v_accvgpr_write_b32 a231, 1.0
v_mfma_f32_16x16x32_bf16 v[136:139], a[76:79], a[4:7], v[136:139]
buffer_load_dwordx4 v8, s[12:15], s33 offen offset:3072 nt lds
v_mfma_f32_16x16x32_bf16 v[140:143], a[76:79], a[12:15], v[164:167]
ds_read_b64_tr_b16 a[66:67], v3 offset:20480
v_accvgpr_write_b32 a232, 1.0
v_mfma_f32_16x16x32_bf16 v[140:143], a[72:75], a[8:11], v[140:143]
s_add_u32 m0, s37, 0x1000
v_accvgpr_write_b32 a233, 1.0
v_accvgpr_write_b32 a234, 1.0
v_mfma_f32_16x16x32_bf16 v[144:147], a[72:75], a[16:19], v[164:167]
ds_read_b64_tr_b16 a[68:69], v3 offset:24576
v_accvgpr_write_b32 a235, 1.0
v_mfma_f32_16x16x32_bf16 v[144:147], a[76:79], a[20:23], v[144:147]
buffer_load_dwordx4 v7, s[12:15], s34 offen nt lds
v_mfma_f32_16x16x32_bf16 v[148:151], a[76:79], a[28:31], v[164:167]
ds_read_b64_tr_b16 a[70:71], v3 offset:28672
v_accvgpr_write_b32 a236, 1.0
v_mfma_f32_16x16x32_bf16 v[148:151], a[72:75], a[24:27], v[148:151]
v_accvgpr_write_b32 a237, 1.0
v_accvgpr_write_b32 a238, 1.0
v_mfma_f32_16x16x32_bf16 v[152:155], a[72:75], a[32:35], v[164:167]
v_accvgpr_write_b32 a239, 1.0
v_accvgpr_write_b32 a240, 1.0
v_mfma_f32_16x16x32_bf16 v[152:155], a[76:79], a[36:39], v[152:155]
buffer_load_dwordx4 v8, s[12:15], s34 offen offset:1024 nt lds
v_mfma_f32_16x16x32_bf16 v[156:159], a[76:79], a[44:47], v[164:167]
v_accvgpr_write_b32 a241, 1.0
v_accvgpr_write_b32 a242, 1.0
v_mfma_f32_16x16x32_bf16 v[156:159], a[72:75], a[40:43], v[156:159]
v_accvgpr_write_b32 a243, 1.0
v_accvgpr_write_b32 a244, 1.0
v_mfma_f32_16x16x32_bf16 v[160:163], a[72:75], a[48:51], v[164:167]
s_add_u32 s41, s41, 1
v_accvgpr_write_b32 a245, 1.0
v_accvgpr_write_b32 a246, 1.0
v_mfma_f32_16x16x32_bf16 v[160:163], a[76:79], a[52:55], v[160:163]
buffer_load_dwordx4 v7, s[12:15], s35 offen offset:2048 nt lds
v_mfma_f32_16x16x32_bf16 v[164:167], a[76:79], a[60:63], v[164:167]
v_accvgpr_write_b32 a247, 1.0
v_accvgpr_write_b32 a248, 1.0
v_mfma_f32_16x16x32_bf16 v[164:167], a[72:75], a[56:59], v[164:167]
s_waitcnt lgkmcnt(0)
v_accvgpr_write_b32 a249, 1.0
v_accvgpr_write_b32 a250, 1.0
v_mfma_f32_16x16x32_bf16 v[168:171], a[64:67], a[0:3], v[196:199]
ds_read_b64_tr_b16 a[72:73], v4 offset:16384
v_accvgpr_write_b32 a251, 1.0
v_mfma_f32_16x16x32_bf16 v[168:171], a[68:71], a[4:7], v[168:171]
buffer_load_dwordx4 v8, s[12:15], s35 offen offset:3072 nt lds
v_mfma_f32_16x16x32_bf16 v[172:175], a[68:71], a[12:15], v[196:199]
ds_read_b64_tr_b16 a[74:75], v4 offset:20480
v_add_u32 v7, 128, v7
v_mfma_f32_16x16x32_bf16 v[172:175], a[64:67], a[8:11], v[172:175]
s_mov_b32 m0, s38
v_add_u32 v8, 128, v8
v_accvgpr_write_b32 a252, 1.0
v_mfma_f32_16x16x32_bf16 v[176:179], a[64:67], a[16:19], v[196:199]
ds_read_b64_tr_b16 a[76:77], v4 offset:24576
v_accvgpr_write_b32 a253, 1.0
v_mfma_f32_16x16x32_bf16 v[176:179], a[68:71], a[20:23], v[176:179]
buffer_load_dwordx4 v7, s[12:15], 0 offen nt lds
v_mfma_f32_16x16x32_bf16 v[180:183], a[68:71], a[28:31], v[196:199]
s_add_u32 s50, s49, 1
ds_read_b64_tr_b16 a[78:79], v4 offset:28672
v_mov_b32 v11, s49
v_mfma_f32_16x16x32_bf16 v[180:183], a[64:67], a[24:27], v[180:183]
v_bfe_u32 v32, v0, 2, 7
v_accvgpr_write_b32 a254, 1.0
v_mfma_f32_16x16x32_bf16 v[184:187], a[64:67], a[32:35], v[196:199]
buffer_store_dword v11, v32, s[16:19], s48 offen sc1
v_mfma_f32_16x16x32_bf16 v[184:187], a[68:71], a[36:39], v[184:187]
buffer_load_dwordx4 v8, s[12:15], 0 offen offset:1024 nt lds
v_mfma_f32_16x16x32_bf16 v[188:191], a[68:71], a[44:47], v[196:199]
v_accvgpr_write_b32 a255, 1.0
v_mfma_f32_16x16x32_bf16 v[188:191], a[64:67], a[40:43], v[188:191]
v_mfma_f32_16x16x32_bf16 v[192:195], a[64:67], a[48:51], v[196:199]
v_mfma_f32_16x16x32_bf16 v[192:195], a[68:71], a[52:55], v[192:195]
buffer_load_dwordx4 v7, s[12:15], s33 offen offset:2048 nt lds
v_mfma_f32_16x16x32_bf16 v[196:199], a[68:71], a[60:63], v[196:199]
v_mfma_f32_16x16x32_bf16 v[196:199], a[64:67], a[56:59], v[196:199]
s_waitcnt lgkmcnt(0)
v_mfma_f32_16x16x32_bf16 v[200:203], a[72:75], a[0:3], v[228:231]
ds_read_b64_tr_b16 a[64:65], v3 offset:16896
v_mfma_f32_16x16x32_bf16 v[200:203], a[76:79], a[4:7], v[200:203]
buffer_load_dwordx4 v8, s[12:15], s33 offen offset:3072 nt lds
v_mfma_f32_16x16x32_bf16 v[204:207], a[76:79], a[12:15], v[228:231]
ds_read_b64_tr_b16 a[66:67], v3 offset:20992
v_mfma_f32_16x16x32_bf16 v[204:207], a[72:75], a[8:11], v[204:207]
s_add_u32 m0, s38, 0x1000
v_mfma_f32_16x16x32_bf16 v[208:211], a[72:75], a[16:19], v[228:231]
s_mov_b32 s5, s36
s_mov_b32 s36, s37
ds_read_b64_tr_b16 a[68:69], v3 offset:25088
v_mfma_f32_16x16x32_bf16 v[208:211], a[76:79], a[20:23], v[208:211]
buffer_load_dwordx4 v7, s[12:15], s34 offen nt lds
v_mfma_f32_16x16x32_bf16 v[212:215], a[76:79], a[28:31], v[228:231]
s_mov_b32 s37, s38
s_mov_b32 s38, s5
ds_read_b64_tr_b16 a[70:71], v3 offset:29184
v_mfma_f32_16x16x32_bf16 v[212:215], a[72:75], a[24:27], v[212:215]
s_mov_b32 s5, s39
s_mov_b32 s39, s40
s_mov_b32 s40, s5
v_mfma_f32_16x16x32_bf16 v[216:219], a[72:75], a[32:35], v[228:231]
v_mfma_f32_16x16x32_bf16 v[216:219], a[76:79], a[36:39], v[216:219]
buffer_load_dwordx4 v8, s[12:15], s34 offen offset:1024 nt lds
v_mfma_f32_16x16x32_bf16 v[220:223], a[76:79], a[44:47], v[228:231]
v_mfma_f32_16x16x32_bf16 v[220:223], a[72:75], a[40:43], v[220:223]
v_mfma_f32_16x16x32_bf16 v[224:227], a[72:75], a[48:51], v[228:231]
v_mfma_f32_16x16x32_bf16 v[224:227], a[76:79], a[52:55], v[224:227]
s_cmp_eq_u32 s68, 0
v_mfma_f32_16x16x32_bf16 v[228:231], a[76:79], a[60:63], v[228:231]
s_cbranch_scc1 CAP_E0
v_mfma_f32_16x16x32_bf16 v[228:231], a[72:75], a[56:59], v[228:231]
s_waitcnt lgkmcnt(0)
v_mfma_f32_16x16x32_bf16 a[216:219], a[64:67], a[0:3], a[216:219]
ds_read_b64_tr_b16 a[72:73], v4 offset:16896
v_mfma_f32_16x16x32_bf16 a[216:219], a[68:71], a[4:7], a[216:219]
v_mfma_f32_16x16x32_bf16 a[220:223], a[68:71], a[12:15], a[220:223]
ds_read_b64_tr_b16 a[74:75], v4 offset:20992
v_mfma_f32_16x16x32_bf16 a[220:223], a[64:67], a[8:11], a[220:223]
v_mfma_f32_16x16x32_bf16 v[232:235], a[64:67], a[16:19], v[252:255]
ds_read_b64_tr_b16 a[76:77], v4 offset:25088
v_mfma_f32_16x16x32_bf16 v[232:235], a[68:71], a[20:23], v[232:235]
v_mfma_f32_16x16x32_bf16 v[236:239], a[68:71], a[28:31], v[252:255]
ds_read_b64_tr_b16 a[78:79], v4 offset:29184
v_mfma_f32_16x16x32_bf16 v[236:239], a[64:67], a[24:27], v[236:239]
CB_E0:
v_mfma_f32_16x16x32_bf16 v[240:243], a[64:67], a[32:35], v[252:255]
buffer_load_dwordx4 v7, s[12:15], s35 offen offset:2048 nt lds
v_mfma_f32_16x16x32_bf16 v[240:243], a[68:71], a[36:39], v[240:243]
buffer_load_dwordx4 v8, s[12:15], s35 offen offset:3072 nt lds
v_mfma_f32_16x16x32_bf16 v[244:247], a[68:71], a[44:47], v[252:255]
v_add_u32 v3, s4, v3
v_add_u32 v4, s4, v4
v_mfma_f32_16x16x32_bf16 v[244:247], a[64:67], a[40:43], v[244:247]
v_mfma_f32_16x16x32_bf16 v[248:251], a[64:67], a[48:51], v[252:255]
v_mfma_f32_16x16x32_bf16 v[248:251], a[68:71], a[52:55], v[248:251]
v_mfma_f32_16x16x32_bf16 v[252:255], a[68:71], a[60:63], v[252:255]
s_nop 0
s_nop 0
L_G0:
v_mfma_f32_16x16x32_bf16 v[252:255], a[64:67], a[56:59], v[252:255]
s_waitcnt vmcnt(9) lgkmcnt(0)
s_barrier
v_mfma_f32_16x16x32_bf16 a[224:227], a[72:75], a[0:3], a[224:227]
s_lshl_b32 s70, s41, 17
s_add_u32 s70, s70, s45
ds_read_b64_tr_b16 a[64:65], v3 offset:0
v_mfma_f32_16x16x32_bf16 a[224:227], a[76:79], a[4:7], a[224:227]
s_sub_u32 s71, s70, s44
s_mov_b32 s44, s70
ds_read_b64_tr_b16 a[66:67], v3 offset:4096
v_mfma_f32_16x16x32_bf16 a[228:231], a[76:79], a[12:15], a[228:231]
ds_read_b64_tr_b16 a[68:69], v3 offset:8192
v_add_u32 v5, s71, v5
v_mfma_f32_16x16x32_bf16 a[228:231], a[72:75], a[8:11], a[228:231]
ds_read_b128 a[0:3], v1 offset:0
v_add_u32 v6, s71, v6
v_mfma_f32_16x16x32_bf16 a[232:235], a[72:75], a[16:19], a[232:235]
ds_read_b128 a[4:7], v2 offset:0
v_mfma_f32_16x16x32_bf16 a[232:235], a[76:79], a[20:23], a[232:235]
ds_read_b128 a[12:15], v2 offset:2048
v_mfma_f32_16x16x32_bf16 a[236:239], a[76:79], a[28:31], a[236:239]
ds_read_b128 a[8:11], v1 offset:2048
v_mfma_f32_16x16x32_bf16 a[236:239], a[72:75], a[24:27], a[236:239]
ds_read_b128 a[16:19], v1 offset:4096
v_mfma_f32_16x16x32_bf16 a[240:243], a[72:75], a[32:35], a[240:243]
ds_read_b64_tr_b16 a[70:71], v3 offset:12288
v_mfma_f32_16x16x32_bf16 a[240:243], a[76:79], a[36:39], a[240:243]
ds_read_b128 a[20:23], v2 offset:4096
v_xor_b32 v36, s61, v1
v_mfma_f32_16x16x32_bf16 a[244:247], a[76:79], a[44:47], a[244:247]
ds_read_b128 a[28:31], v2 offset:6144
v_mfma_f32_16x16x32_bf16 a[244:247], a[72:75], a[40:43], a[244:247]
ds_read_b128 a[24:27], v1 offset:6144
v_mfma_f32_16x16x32_bf16 a[248:251], a[72:75], a[48:51], a[248:251]
s_mov_b32 m0, s40
ds_read_b128 a[32:35], v1 offset:8192
v_mfma_f32_16x16x32_bf16 a[248:251], a[76:79], a[52:55], a[248:251]
ds_read_b128 a[36:39], v2 offset:8192
v_mfma_f32_16x16x32_bf16 a[252:255], a[76:79], a[60:63], a[252:255]
buffer_load_dwordx4 v5, s[8:11], 0 offen lds
v_mfma_f32_16x16x32_bf16 a[252:255], a[72:75], a[56:59], a[252:255]
s_waitcnt lgkmcnt(5)
ds_read_b128 a[44:47], v2 offset:10240
v_mfma_f32_16x16x32_bf16 v[40:43], a[64:67], a[0:3], v[40:43]
ds_read_b128 a[40:43], v1 offset:10240
v_mfma_f32_16x16x32_bf16 v[40:43], a[68:71], a[4:7], v[40:43]
ds_read_b128 a[48:51], v1 offset:12288
v_mfma_f32_16x16x32_bf16 v[44:47], a[68:71], a[12:15], v[44:47]
ds_read_b128 a[52:55], v2 offset:12288
v_mfma_f32_16x16x32_bf16 v[44:47], a[64:67], a[8:11], v[44:47]
s_waitcnt lgkmcnt(6)
ds_read_b128 a[60:63], v2 offset:14336
v_mfma_f32_16x16x32_bf16 v[48:51], a[64:67], a[16:19], v[48:51]
ds_read_b64_tr_b16 a[72:73], v4 offset:0
v_mfma_f32_16x16x32_bf16 v[48:51], a[68:71], a[20:23], v[48:51]
ds_read_b128 a[56:59], v1 offset:14336
v_mfma_f32_16x16x32_bf16 v[52:55], a[68:71], a[28:31], v[52:55]
s_sub_u32 s79, s37, s36
ds_read_b64_tr_b16 a[74:75], v4 offset:4096
v_add_u32 v1, s79, v1
v_mfma_f32_16x16x32_bf16 v[52:55], a[64:67], a[24:27], v[52:55]
s_waitcnt lgkmcnt(8)
ds_read_b64_tr_b16 a[76:77], v4 offset:8192
v_add_u32 v2, s79, v2
v_mfma_f32_16x16x32_bf16 v[56:59], a[64:67], a[32:35], v[56:59]
s_sub_u32 s4, s40, s39
ds_read_b64_tr_b16 a[78:79], v4 offset:12288
v_mfma_f32_16x16x32_bf16 v[56:59], a[68:71], a[36:39], v[56:59]
s_waitcnt lgkmcnt(8)
v_mfma_f32_16x16x32_bf16 v[60:63], a[68:71], a[44:47], v[60:63]
buffer_load_dwordx4 v6, s[8:11], 0 offen offset:1024 lds
v_mfma_f32_16x16x32_bf16 v[60:63], a[64:67], a[40:43], v[60:63]
s_waitcnt lgkmcnt(6)
v_mfma_f32_16x16x32_bf16 v[64:67], a[64:67], a[48:51], v[64:67]
buffer_load_dwordx4 v5, s[8:11], s29 offen offset:2048 lds
v_mfma_f32_16x16x32_bf16 v[64:67], a[68:71], a[52:55], v[64:67]
s_waitcnt lgkmcnt(3)
v_mfma_f32_16x16x32_bf16 v[68:71], a[68:71], a[60:63], v[68:71]
v_mfma_f32_16x16x32_bf16 v[68:71], a[64:67], a[56:59], v[68:71]
s_waitcnt lgkmcnt(0)
v_mfma_f32_16x16x32_bf16 v[72:75], a[72:75], a[0:3], v[72:75]
ds_read_b64_tr_b16 a[64:65], v3 offset:512
v_mfma_f32_16x16x32_bf16 v[72:75], a[76:79], a[4:7], v[72:75]
v_mfma_f32_16x16x32_bf16 v[76:79], a[76:79], a[12:15], v[76:79]
ds_read_b64_tr_b16 a[66:67], v3 offset:4608
v_mfma_f32_16x16x32_bf16 v[76:79], a[72:75], a[8:11], v[76:79]
buffer_load_dwordx4 v6, s[8:11], s29 offen offset:3072 lds
v_mfma_f32_16x16x32_bf16 v[80:83], a[72:75], a[16:19], v[80:83]
ds_read_b64_tr_b16 a[68:69], v3 offset:8704
v_add_u32 v7, 128, v7
v_mfma_f32_16x16x32_bf16 v[80:83], a[76:79], a[20:23], v[80:83]
v_add_u32 v8, 128, v8
v_mfma_f32_16x16x32_bf16 v[84:87], a[76:79], a[28:31], v[84:87]
ds_read_b64_tr_b16 a[70:71], v3 offset:12800
v_mfma_f32_16x16x32_bf16 v[84:87], a[72:75], a[24:27], v[84:87]
v_mfma_f32_16x16x32_bf16 v[88:91], a[72:75], a[32:35], v[88:91]
s_add_u32 m0, s40, 0x1000
v_mfma_f32_16x16x32_bf16 v[88:91], a[76:79], a[36:39], v[88:91]
v_mfma_f32_16x16x32_bf16 v[92:95], a[76:79], a[44:47], v[92:95]
buffer_load_dwordx4 v5, s[8:11], s30 offen lds
v_mfma_f32_16x16x32_bf16 v[92:95], a[72:75], a[40:43], v[92:95]
v_mfma_f32_16x16x32_bf16 v[96:99], a[72:75], a[48:51], v[96:99]
v_mfma_f32_16x16x32_bf16 v[96:99], a[76:79], a[52:55], v[96:99]
v_mfma_f32_16x16x32_bf16 v[100:103], a[76:79], a[60:63], v[100:103]
v_mfma_f32_16x16x32_bf16 v[100:103], a[72:75], a[56:59], v[100:103]
s_waitcnt lgkmcnt(0)
v_mfma_f32_16x16x32_bf16 v[104:107], a[64:67], a[0:3], v[104:107]
ds_read_b64_tr_b16 a[72:73], v4 offset:512
v_mfma_f32_16x16x32_bf16 v[104:107], a[68:71], a[4:7], v[104:107]
buffer_load_dwordx4 v6, s[8:11], s30 offen offset:1024 lds
v_mfma_f32_16x16x32_bf16 v[108:111], a[68:71], a[12:15], v[108:111]
ds_read_b64_tr_b16 a[74:75], v4 offset:4608
v_mfma_f32_16x16x32_bf16 v[108:111], a[64:67], a[8:11], v[108:111]
v_mfma_f32_16x16x32_bf16 v[112:115], a[64:67], a[16:19], v[112:115]
ds_read_b64_tr_b16 a[76:77], v4 offset:8704
v_mfma_f32_16x16x32_bf16 v[112:115], a[68:71], a[20:23], v[112:115]
v_mfma_f32_16x16x32_bf16 v[116:119], a[68:71], a[28:31], v[116:119]
ds_read_b64_tr_b16 a[78:79], v4 offset:12800
v_mfma_f32_16x16x32_bf16 v[116:119], a[64:67], a[24:27], v[116:119]
v_mfma_f32_16x16x32_bf16 v[120:123], a[64:67], a[32:35], v[120:123]
buffer_load_dwordx4 v5, s[8:11], s31 offen offset:2048 lds
v_mfma_f32_16x16x32_bf16 v[120:123], a[68:71], a[36:39], v[120:123]
v_mfma_f32_16x16x32_bf16 v[124:127], a[68:71], a[44:47], v[124:127]
v_mfma_f32_16x16x32_bf16 v[124:127], a[64:67], a[40:43], v[124:127]
v_mfma_f32_16x16x32_bf16 v[128:131], a[64:67], a[48:51], v[128:131]
v_mfma_f32_16x16x32_bf16 v[128:131], a[68:71], a[52:55], v[128:131]
v_mfma_f32_16x16x32_bf16 v[132:135], a[68:71], a[60:63], v[132:135]
v_mfma_f32_16x16x32_bf16 v[132:135], a[64:67], a[56:59], v[132:135]
s_waitcnt lgkmcnt(0)
v_mfma_f32_16x16x32_bf16 v[136:139], a[72:75], a[0:3], v[136:139]
ds_read_b64_tr_b16 a[64:65], v3 offset:16384
v_mfma_f32_16x16x32_bf16 v[136:139], a[76:79], a[4:7], v[136:139]
buffer_load_dwordx4 v6, s[8:11], s31 offen offset:3072 lds
v_mfma_f32_16x16x32_bf16 v[140:143], a[76:79], a[12:15], v[140:143]
ds_read_b64_tr_b16 a[66:67], v3 offset:20480
v_mfma_f32_16x16x32_bf16 v[140:143], a[72:75], a[8:11], v[140:143]
v_mfma_f32_16x16x32_bf16 v[144:147], a[72:75], a[16:19], v[144:147]
ds_read_b64_tr_b16 a[68:69], v3 offset:24576
v_mfma_f32_16x16x32_bf16 v[144:147], a[76:79], a[20:23], v[144:147]
buffer_load_dword v10, v9, s[8:11], s53 offen
v_mfma_f32_16x16x32_bf16 v[148:151], a[76:79], a[28:31], v[148:151]
s_add_u32 s53, s53, 384
s_mov_b32 m0, s38
ds_read_b64_tr_b16 a[70:71], v3 offset:28672
v_mfma_f32_16x16x32_bf16 v[148:151], a[72:75], a[24:27], v[148:151]
v_mfma_f32_16x16x32_bf16 v[152:155], a[72:75], a[32:35], v[152:155]
buffer_load_dwordx4 v7, s[12:15], 0 offen nt lds
v_mfma_f32_16x16x32_bf16 v[152:155], a[76:79], a[36:39], v[152:155]
v_mfma_f32_16x16x32_bf16 v[156:159], a[76:79], a[44:47], v[156:159]
v_mfma_f32_16x16x32_bf16 v[156:159], a[72:75], a[40:43], v[156:159]
v_mfma_f32_16x16x32_bf16 v[160:163], a[72:75], a[48:51], v[160:163]
s_add_u32 s41, s41, 1
v_mfma_f32_16x16x32_bf16 v[160:163], a[76:79], a[52:55], v[160:163]
v_mfma_f32_16x16x32_bf16 v[164:167], a[76:79], a[60:63], v[164:167]
v_mfma_f32_16x16x32_bf16 v[164:167], a[72:75], a[56:59], v[164:167]
s_waitcnt lgkmcnt(0)
v_mfma_f32_16x16x32_bf16 v[168:171], a[64:67], a[0:3], v[168:171]
s_lshl_b32 s72, s68, 2
s_sub_u32 s72, s57, s72
ds_read_b64_tr_b16 a[72:73], v4 offset:16384
v_mfma_f32_16x16x32_bf16 v[168:171], a[68:71], a[4:7], v[168:171]
buffer_load_dwordx4 v8, s[12:15], 0 offen offset:1024 nt lds
v_mfma_f32_16x16x32_bf16 v[172:175], a[68:71], a[12:15], v[172:175]
ds_read_b64_tr_b16 a[74:75], v4 offset:20480
v_mfma_f32_16x16x32_bf16 v[172:175], a[64:67], a[8:11], v[172:175]
v_mfma_f32_16x16x32_bf16 v[176:179], a[64:67], a[16:19], v[176:179]
ds_read_b64_tr_b16 a[76:77], v4 offset:24576
v_mfma_f32_16x16x32_bf16 v[176:179], a[68:71], a[20:23], v[176:179]
v_mfma_f32_16x16x32_bf16 v[180:183], a[68:71], a[28:31], v[180:183]
ds_read_b64_tr_b16 a[78:79], v4 offset:28672
v_mfma_f32_16x16x32_bf16 v[180:183], a[64:67], a[24:27], v[180:183]
buffer_load_dwordx4 v7, s[12:15], s33 offen offset:2048 nt lds
v_mfma_f32_16x16x32_bf16 v[184:187], a[64:67], a[32:35], v[184:187]
v_mfma_f32_16x16x32_bf16 v[184:187], a[68:71], a[36:39], v[184:187]
v_mfma_f32_16x16x32_bf16 v[188:191], a[68:71], a[44:47], v[188:191]
v_mfma_f32_16x16x32_bf16 v[188:191], a[64:67], a[40:43], v[188:191]
v_mfma_f32_16x16x32_bf16 v[192:195], a[64:67], a[48:51], v[192:195]
v_mfma_f32_16x16x32_bf16 v[192:195], a[68:71], a[52:55], v[192:195]
v_mfma_f32_16x16x32_bf16 v[196:199], a[68:71], a[60:63], v[196:199]
buffer_load_dwordx4 v8, s[12:15], s33 offen offset:3072 nt lds
v_mfma_f32_16x16x32_bf16 v[196:199], a[64:67], a[56:59], v[196:199]
s_waitcnt lgkmcnt(0)
v_mfma_f32_16x16x32_bf16 v[200:203], a[72:75], a[0:3], v[200:203]
s_cmp_eq_u32 s72, 0
ds_read_b64_tr_b16 a[64:65], v3 offset:16896
v_mfma_f32_16x16x32_bf16 v[200:203], a[76:79], a[4:7], v[200:203]
s_cbranch_scc1 CAP_G00
v_mfma_f32_16x16x32_bf16 v[204:207], a[76:79], a[12:15], v[204:207]
s_cmp_eq_u32 s72, 1
ds_read_b64_tr_b16 a[66:67], v3 offset:20992
v_mfma_f32_16x16x32_bf16 v[204:207], a[72:75], a[8:11], v[204:207]
s_cbranch_scc1 CAP_G01
v_mfma_f32_16x16x32_bf16 v[208:211], a[72:75], a[16:19], v[208:211]
s_cmp_eq_u32 s72, 2
ds_read_b64_tr_b16 a[68:69], v3 offset:25088
v_mfma_f32_16x16x32_bf16 v[208:211], a[76:79], a[20:23], v[208:211]
s_cbranch_scc1 CAP_G02
v_mfma_f32_16x16x32_bf16 v[212:215], a[76:79], a[28:31], v[212:215]
s_cmp_eq_u32 s72, 3
ds_read_b64_tr_b16 a[70:71], v3 offset:29184
v_mfma_f32_16x16x32_bf16 v[212:215], a[72:75], a[24:27], v[212:215]
s_cbranch_scc1 CAP_G03
v_mfma_f32_16x16x32_bf16 v[216:219], a[72:75], a[32:35], v[216:219]
s_add_u32 m0, s38, 0x1000
v_mfma_f32_16x16x32_bf16 v[216:219], a[76:79], a[36:39], v[216:219]
buffer_load_dwordx4 v7, s[12:15], s34 offen nt lds
v_mfma_f32_16x16x32_bf16 v[220:223], a[76:79], a[44:47], v[220:223]
s_mov_b32 s5, s36
s_mov_b32 s36, s37
s_mov_b32 s37, s38
v_mfma_f32_16x16x32_bf16 v[220:223], a[72:75], a[40:43], v[220:223]
s_mov_b32 s38, s5
s_mov_b32 s5, s39
s_mov_b32 s39, s40
v_mfma_f32_16x16x32_bf16 v[224:227], a[72:75], a[48:51], v[224:227]
s_mov_b32 s40, s5
v_mfma_f32_16x16x32_bf16 v[224:227], a[76:79], a[52:55], v[224:227]
buffer_load_dwordx4 v8, s[12:15], s34 offen offset:1024 nt lds
v_mfma_f32_16x16x32_bf16 v[228:231], a[76:79], a[60:63], v[228:231]
v_mfma_f32_16x16x32_bf16 v[228:231], a[72:75], a[56:59], v[228:231]
s_waitcnt lgkmcnt(0)
v_mfma_f32_16x16x32_bf16 a[216:219], a[64:67], a[0:3], a[216:219]
ds_read_b64_tr_b16 a[72:73], v4 offset:16896
v_mfma_f32_16x16x32_bf16 a[216:219], a[68:71], a[4:7], a[216:219]
v_mfma_f32_16x16x32_bf16 a[220:223], a[68:71], a[12:15], a[220:223]
ds_read_b64_tr_b16 a[74:75], v4 offset:20992
v_mfma_f32_16x16x32_bf16 a[220:223], a[64:67], a[8:11], a[220:223]
v_mfma_f32_16x16x32_bf16 v[232:235], a[64:67], a[16:19], v[232:235]
ds_read_b64_tr_b16 a[76:77], v4 offset:25088
v_mfma_f32_16x16x32_bf16 v[232:235], a[68:71], a[20:23], v[232:235]
buffer_load_dwordx4 v7, s[12:15], s35 offen offset:2048 nt lds
v_mfma_f32_16x16x32_bf16 v[236:239], a[68:71], a[28:31], v[236:239]
ds_read_b64_tr_b16 a[78:79], v4 offset:29184
v_mfma_f32_16x16x32_bf16 v[236:239], a[64:67], a[24:27], v[236:239]
v_mfma_f32_16x16x32_bf16 v[240:243], a[64:67], a[32:35], v[240:243]
CB_G0:
v_mfma_f32_16x16x32_bf16 v[240:243], a[68:71], a[36:39], v[240:243]
s_add_u32 s57, s57, 1
v_add_u32 v3, s4, v3
v_add_u32 v4, s4, v4
v_mfma_f32_16x16x32_bf16 v[244:247], a[68:71], a[44:47], v[244:247]
v_mfma_f32_16x16x32_bf16 v[244:247], a[64:67], a[40:43], v[244:247]
v_mfma_f32_16x16x32_bf16 v[248:251], a[64:67], a[48:51], v[248:251]
buffer_load_dwordx4 v8, s[12:15], s35 offen offset:3072 nt lds
v_mfma_f32_16x16x32_bf16 v[248:251], a[68:71], a[52:55], v[248:251]
s_cmp_lt_u32 s57, 14
v_mfma_f32_16x16x32_bf16 v[252:255], a[68:71], a[60:63], v[252:255]
s_cbranch_scc1 L_G0
L_T14:
v_mfma_f32_16x16x32_bf16 v[252:255], a[64:67], a[56:59], v[252:255]
s_waitcnt vmcnt(8) lgkmcnt(0)
s_barrier
v_mfma_f32_16x16x32_bf16 a[224:227], a[72:75], a[0:3], a[224:227]
s_lshl_b32 s70, s41, 17
s_add_u32 s70, s70, s45
ds_read_b64_tr_b16 a[64:65], v3 offset:0
v_mfma_f32_16x16x32_bf16 a[224:227], a[76:79], a[4:7], a[224:227]
s_sub_u32 s71, s70, s44
s_mov_b32 s44, s70
ds_read_b64_tr_b16 a[66:67], v3 offset:4096
v_mfma_f32_16x16x32_bf16 a[228:231], a[76:79], a[12:15], a[228:231]
ds_read_b64_tr_b16 a[68:69], v3 offset:8192
v_add_u32 v5, s71, v5
v_mfma_f32_16x16x32_bf16 a[228:231], a[72:75], a[8:11], a[228:231]
ds_read_b128 a[0:3], v1 offset:0
v_add_u32 v6, s71, v6
v_mfma_f32_16x16x32_bf16 a[232:235], a[72:75], a[16:19], a[232:235]
ds_read_b128 a[4:7], v2 offset:0
v_mov_b32_dpp v33, v38 row_newbcast:7 row_mask:0xf bank_mask:0xf
v_mfma_f32_16x16x32_bf16 a[232:235], a[76:79], a[20:23], a[232:235]
ds_read_b128 a[12:15], v2 offset:2048
v_mov_b32_dpp v35, v39 row_newbcast:7 row_mask:0xf bank_mask:0xf
v_mfma_f32_16x16x32_bf16 a[236:239], a[76:79], a[28:31], a[236:239]
ds_read_b128 a[8:11], v1 offset:2048
v_lshlrev_b32 v32, 16, v33
v_mfma_f32_16x16x32_bf16 a[236:239], a[72:75], a[24:27], a[236:239]
ds_read_b128 a[16:19], v1 offset:4096
v_and_b32 v33, s65, v33
v_mfma_f32_16x16x32_bf16 a[240:243], a[72:75], a[32:35], a[240:243]
ds_read_b64_tr_b16 a[70:71], v3 offset:12288
v_lshlrev_b32 v34, 16, v35
v_mfma_f32_16x16x32_bf16 a[240:243], a[76:79], a[36:39], a[240:243]
ds_read_b128 a[20:23], v2 offset:4096
v_xor_b32 v36, s61, v1
v_mfma_f32_16x16x32_bf16 a[244:247], a[76:79], a[44:47], a[244:247]
ds_read_b128 a[28:31], v2 offset:6144
v_and_b32 v35, s65, v35
v_mfma_f32_16x16x32_bf16 a[244:247], a[72:75], a[40:43], a[244:247]
ds_read_b128 a[24:27], v1 offset:6144
v_mfma_f32_16x16x32_bf16 a[248:251], a[72:75], a[48:51], a[248:251]
s_mov_b32 m0, s40
ds_read_b128 a[32:35], v1 offset:8192
v_mfma_f32_16x16x32_bf16 a[248:251], a[76:79], a[52:55], a[248:251]
ds_read_b128 a[36:39], v2 offset:8192
v_mfma_f32_16x16x32_bf16 a[252:255], a[76:79], a[60:63], a[252:255]
buffer_load_dwordx4 v5, s[8:11], 0 offen lds
v_mfma_f32_16x16x32_bf16 a[252:255], a[72:75], a[56:59], a[252:255]
s_waitcnt lgkmcnt(5)
ds_read_b128 a[44:47], v2 offset:10240
v_mfma_f32_16x16x32_bf16 v[40:43], a[64:67], a[0:3], v[40:43]
ds_read_b128 a[40:43], v1 offset:10240
v_mfma_f32_16x16x32_bf16 v[40:43], a[68:71], a[4:7], v[40:43]
ds_read_b128 a[48:51], v1 offset:12288
v_mfma_f32_16x16x32_bf16 v[44:47], a[68:71], a[12:15], v[44:47]
ds_read_b128 a[52:55], v2 offset:12288
v_mfma_f32_16x16x32_bf16 v[44:47], a[64:67], a[8:11], v[44:47]
s_waitcnt lgkmcnt(6)
ds_read_b128 a[60:63], v2 offset:14336
v_mfma_f32_16x16x32_bf16 v[48:51], a[64:67], a[16:19], v[48:51]
ds_read_b64_tr_b16 a[72:73], v4 offset:0
v_mfma_f32_16x16x32_bf16 v[48:51], a[68:71], a[20:23], v[48:51]
ds_read_b128 a[56:59], v1 offset:14336
v_mfma_f32_16x16x32_bf16 v[52:55], a[68:71], a[28:31], v[52:55]
s_sub_u32 s79, s37, s36
ds_read_b64_tr_b16 a[74:75], v4 offset:4096
v_add_u32 v1, s79, v1
v_mfma_f32_16x16x32_bf16 v[52:55], a[64:67], a[24:27], v[52:55]
s_waitcnt lgkmcnt(8)
ds_read_b64_tr_b16 a[76:77], v4 offset:8192
v_add_u32 v2, s79, v2
v_mfma_f32_16x16x32_bf16 v[56:59], a[64:67], a[32:35], v[56:59]
s_sub_u32 s4, s40, s39
ds_read_b64_tr_b16 a[78:79], v4 offset:12288
v_accvgpr_read_b32 v26, a224
v_mfma_f32_16x16x32_bf16 v[56:59], a[68:71], a[36:39], v[56:59]
s_waitcnt lgkmcnt(8)
v_accvgpr_read_b32 v27, a225
v_add_f32 v26, v26, v32
v_mfma_f32_16x16x32_bf16 v[60:63], a[68:71], a[44:47], v[60:63]
buffer_load_dwordx4 v6, s[8:11], 0 offen offset:1024 lds
v_mfma_f32_16x16x32_bf16 v[60:63], a[64:67], a[40:43], v[60:63]
s_waitcnt lgkmcnt(6)
v_add_f32 v27, v27, v33
v_accvgpr_write_b32 a224, v26
v_mfma_f32_16x16x32_bf16 v[64:67], a[64:67], a[48:51], v[64:67]
buffer_load_dwordx4 v5, s[8:11], s29 offen offset:2048 lds
v_mfma_f32_16x16x32_bf16 v[64:67], a[68:71], a[52:55], v[64:67]
s_waitcnt lgkmcnt(3)
v_accvgpr_write_b32 a225, v27
v_accvgpr_read_b32 v26, a226
v_mfma_f32_16x16x32_bf16 v[68:71], a[68:71], a[60:63], v[68:71]
v_accvgpr_read_b32 v27, a227
v_add_f32 v26, v26, v34
v_mfma_f32_16x16x32_bf16 v[68:71], a[64:67], a[56:59], v[68:71]
s_waitcnt lgkmcnt(0)
v_add_f32 v27, v27, v35
v_accvgpr_write_b32 a226, v26
v_mfma_f32_16x16x32_bf16 v[72:75], a[72:75], a[0:3], v[72:75]
ds_read_b64_tr_b16 a[64:65], v3 offset:512
v_accvgpr_write_b32 a227, v27
v_mfma_f32_16x16x32_bf16 v[72:75], a[76:79], a[4:7], v[72:75]
v_accvgpr_read_b32 v26, a228
v_accvgpr_read_b32 v27, a229
v_mfma_f32_16x16x32_bf16 v[76:79], a[76:79], a[12:15], v[76:79]
ds_read_b64_tr_b16 a[66:67], v3 offset:4608
v_add_f32 v26, v26, v32
v_mfma_f32_16x16x32_bf16 v[76:79], a[72:75], a[8:11], v[76:79]
buffer_load_dwordx4 v6, s[8:11], s29 offen offset:3072 lds
v_mfma_f32_16x16x32_bf16 v[80:83], a[72:75], a[16:19], v[80:83]
ds_read_b64_tr_b16 a[68:69], v3 offset:8704
v_add_f32 v27, v27, v33
v_mfma_f32_16x16x32_bf16 v[80:83], a[76:79], a[20:23], v[80:83]
v_accvgpr_write_b32 a228, v26
v_accvgpr_write_b32 a229, v27
v_mfma_f32_16x16x32_bf16 v[84:87], a[76:79], a[28:31], v[84:87]
ds_read_b64_tr_b16 a[70:71], v3 offset:12800
v_accvgpr_read_b32 v26, a230
v_mfma_f32_16x16x32_bf16 v[84:87], a[72:75], a[24:27], v[84:87]
v_accvgpr_read_b32 v27, a231
v_add_f32 v26, v26, v34
v_mfma_f32_16x16x32_bf16 v[88:91], a[72:75], a[32:35], v[88:91]
s_add_u32 m0, s40, 0x1000
v_add_f32 v27, v27, v35
v_accvgpr_write_b32 a230, v26
v_mfma_f32_16x16x32_bf16 v[88:91], a[76:79], a[36:39], v[88:91]
v_accvgpr_write_b32 a231, v27
v_accvgpr_read_b32 v26, a232
v_mfma_f32_16x16x32_bf16 v[92:95], a[76:79], a[44:47], v[92:95]
buffer_load_dwordx4 v5, s[8:11], s30 offen lds
v_mfma_f32_16x16x32_bf16 v[92:95], a[72:75], a[40:43], v[92:95]
v_accvgpr_read_b32 v27, a233
v_add_f32 v26, v26, v32
v_mfma_f32_16x16x32_bf16 v[96:99], a[72:75], a[48:51], v[96:99]
v_add_f32 v27, v27, v33
v_accvgpr_write_b32 a232, v26
v_mfma_f32_16x16x32_bf16 v[96:99], a[76:79], a[52:55], v[96:99]
v_accvgpr_write_b32 a233, v27
v_accvgpr_read_b32 v26, a234
v_mfma_f32_16x16x32_bf16 v[100:103], a[76:79], a[60:63], v[100:103]
v_accvgpr_read_b32 v27, a235
v_add_f32 v26, v26, v34
v_mfma_f32_16x16x32_bf16 v[100:103], a[72:75], a[56:59], v[100:103]
s_waitcnt lgkmcnt(0)
v_add_f32 v27, v27, v35
v_accvgpr_write_b32 a234, v26
v_mfma_f32_16x16x32_bf16 v[104:107], a[64:67], a[0:3], v[104:107]
ds_read_b64_tr_b16 a[72:73], v4 offset:512
v_accvgpr_write_b32 a235, v27
v_mfma_f32_16x16x32_bf16 v[104:107], a[68:71], a[4:7], v[104:107]
buffer_load_dwordx4 v6, s[8:11], s30 offen offset:1024 lds
v_mfma_f32_16x16x32_bf16 v[108:111], a[68:71], a[12:15], v[108:111]
ds_read_b64_tr_b16 a[74:75], v4 offset:4608
v_accvgpr_read_b32 v26, a236
v_mfma_f32_16x16x32_bf16 v[108:111], a[64:67], a[8:11], v[108:111]
v_accvgpr_read_b32 v27, a237
v_add_f32 v26, v26, v32
v_mfma_f32_16x16x32_bf16 v[112:115], a[64:67], a[16:19], v[112:115]
ds_read_b64_tr_b16 a[76:77], v4 offset:8704
v_add_f32 v27, v27, v33
v_mfma_f32_16x16x32_bf16 v[112:115], a[68:71], a[20:23], v[112:115]
v_accvgpr_write_b32 a236, v26
v_accvgpr_write_b32 a237, v27
v_mfma_f32_16x16x32_bf16 v[116:119], a[68:71], a[28:31], v[116:119]
ds_read_b64_tr_b16 a[78:79], v4 offset:12800
v_accvgpr_read_b32 v26, a238
v_mfma_f32_16x16x32_bf16 v[116:119], a[64:67], a[24:27], v[116:119]
v_accvgpr_read_b32 v27, a239
v_add_f32 v26, v26, v34
v_mfma_f32_16x16x32_bf16 v[120:123], a[64:67], a[32:35], v[120:123]
HOP2:
s_cbranch_execz HOP6
buffer_load_dwordx4 v5, s[8:11], s31 offen offset:2048 lds
v_mfma_f32_16x16x32_bf16 v[120:123], a[68:71], a[36:39], v[120:123]
v_add_f32 v27, v27, v35
v_accvgpr_write_b32 a238, v26
v_mfma_f32_16x16x32_bf16 v[124:127], a[68:71], a[44:47], v[124:127]
v_accvgpr_write_b32 a239, v27
v_accvgpr_read_b32 v26, a240
v_mfma_f32_16x16x32_bf16 v[124:127], a[64:67], a[40:43], v[124:127]
v_accvgpr_read_b32 v27, a241
v_add_f32 v26, v26, v32
v_mfma_f32_16x16x32_bf16 v[128:131], a[64:67], a[48:51], v[128:131]
v_add_f32 v27, v27, v33
v_accvgpr_write_b32 a240, v26
v_mfma_f32_16x16x32_bf16 v[128:131], a[68:71], a[52:55], v[128:131]
v_accvgpr_write_b32 a241, v27
v_accvgpr_read_b32 v26, a242
v_mfma_f32_16x16x32_bf16 v[132:135], a[68:71], a[60:63], v[132:135]
v_accvgpr_read_b32 v27, a243
v_add_f32 v26, v26, v34
v_mfma_f32_16x16x32_bf16 v[132:135], a[64:67], a[56:59], v[132:135]
s_waitcnt lgkmcnt(0)
v_add_f32 v27, v27, v35
v_accvgpr_write_b32 a242, v26
v_mfma_f32_16x16x32_bf16 v[136:139], a[72:75], a[0:3], v[136:139]
ds_read_b64_tr_b16 a[64:65], v3 offset:16384
v_accvgpr_write_b32 a243, v27
v_mfma_f32_16x16x32_bf16 v[136:139], a[76:79], a[4:7], v[136:139]
buffer_load_dwordx4 v6, s[8:11], s31 offen offset:3072 lds
v_mfma_f32_16x16x32_bf16 v[140:143], a[76:79], a[12:15], v[140:143]
s_mov_b32 s29, 14336
s_mov_b32 s30, 32768
ds_read_b64_tr_b16 a[66:67], v3 offset:20480
v_mfma_f32_16x16x32_bf16 v[140:143], a[72:75], a[8:11], v[140:143]
s_mov_b32 s31, 47104
s_add_u32 s45, s45, 0x200000
s_lshl_b32 s41, s54, 2
v_mfma_f32_16x16x32_bf16 v[144:147], a[72:75], a[16:19], v[144:147]
ds_read_b64_tr_b16 a[68:69], v3 offset:24576
v_subrev_u32 v6, s59, v6
v_mfma_f32_16x16x32_bf16 v[144:147], a[76:79], a[20:23], v[144:147]
s_mov_b32 s59, 0
s_lshl_b32 s70, s41, 17
s_add_u32 s70, s70, s45
v_mfma_f32_16x16x32_bf16 v[148:151], a[76:79], a[28:31], v[148:151]
s_sub_u32 s71, s70, s44
s_mov_b32 s44, s70
ds_read_b64_tr_b16 a[70:71], v3 offset:28672
v_mfma_f32_16x16x32_bf16 v[148:151], a[72:75], a[24:27], v[148:151]
s_mov_b32 m0, s38
v_add_u32 v5, s71, v5
v_add_u32 v6, s71, v6
v_mfma_f32_16x16x32_bf16 v[152:155], a[72:75], a[32:35], v[152:155]
buffer_load_dwordx4 v5, s[8:11], 0 offen lds
v_mfma_f32_16x16x32_bf16 v[152:155], a[76:79], a[36:39], v[152:155]
v_accvgpr_read_b32 v26, a244
v_accvgpr_read_b32 v27, a245
v_mfma_f32_16x16x32_bf16 v[156:159], a[76:79], a[44:47], v[156:159]
v_add_f32 v26, v26, v32
v_add_f32 v27, v27, v33
v_mfma_f32_16x16x32_bf16 v[156:159], a[72:75], a[40:43], v[156:159]
v_accvgpr_write_b32 a244, v26
v_accvgpr_write_b32 a245, v27
v_mfma_f32_16x16x32_bf16 v[160:163], a[72:75], a[48:51], v[160:163]
v_accvgpr_read_b32 v26, a246
v_accvgpr_read_b32 v27, a247
v_mfma_f32_16x16x32_bf16 v[160:163], a[76:79], a[52:55], v[160:163]
v_add_f32 v26, v26, v34
v_add_f32 v27, v27, v35
v_mfma_f32_16x16x32_bf16 v[164:167], a[76:79], a[60:63], v[164:167]
buffer_load_dwordx4 v6, s[8:11], 0 offen offset:1024 lds
v_mfma_f32_16x16x32_bf16 v[164:167], a[72:75], a[56:59], v[164:167]
s_waitcnt lgkmcnt(0)
v_accvgpr_write_b32 a246, v26
v_accvgpr_write_b32 a247, v27
v_mfma_f32_16x16x32_bf16 v[168:171], a[64:67], a[0:3], v[168:171]
ds_read_b64_tr_b16 a[72:73], v4 offset:16384
v_accvgpr_read_b32 v26, a248
v_mfma_f32_16x16x32_bf16 v[168:171], a[68:71], a[4:7], v[168:171]
v_accvgpr_read_b32 v27, a249
v_add_f32 v26, v26, v32
v_mfma_f32_16x16x32_bf16 v[172:175], a[68:71], a[12:15], v[172:175]
ds_read_b64_tr_b16 a[74:75], v4 offset:20480
v_add_f32 v27, v27, v33
v_mfma_f32_16x16x32_bf16 v[172:175], a[64:67], a[8:11], v[172:175]
v_accvgpr_write_b32 a248, v26
v_accvgpr_write_b32 a249, v27
v_mfma_f32_16x16x32_bf16 v[176:179], a[64:67], a[16:19], v[176:179]
ds_read_b64_tr_b16 a[76:77], v4 offset:24576
v_accvgpr_read_b32 v26, a250
v_mfma_f32_16x16x32_bf16 v[176:179], a[68:71], a[20:23], v[176:179]
buffer_load_dwordx4 v5, s[8:11], s29 offen offset:2048 lds
v_mfma_f32_16x16x32_bf16 v[180:183], a[68:71], a[28:31], v[180:183]
ds_read_b64_tr_b16 a[78:79], v4 offset:28672
v_accvgpr_read_b32 v27, a251
v_mfma_f32_16x16x32_bf16 v[180:183], a[64:67], a[24:27], v[180:183]
v_add_f32 v26, v26, v34
v_add_f32 v27, v27, v35
v_mfma_f32_16x16x32_bf16 v[184:187], a[64:67], a[32:35], v[184:187]
v_accvgpr_write_b32 a250, v26
v_accvgpr_write_b32 a251, v27
v_mfma_f32_16x16x32_bf16 v[184:187], a[68:71], a[36:39], v[184:187]
v_accvgpr_read_b32 v26, a252
v_accvgpr_read_b32 v27, a253
v_mfma_f32_16x16x32_bf16 v[188:191], a[68:71], a[44:47], v[188:191]
buffer_load_dwordx4 v6, s[8:11], s29 offen offset:3072 lds
v_mfma_f32_16x16x32_bf16 v[188:191], a[64:67], a[40:43], v[188:191]
v_add_f32 v26, v26, v32
v_add_f32 v27, v27, v33
v_mfma_f32_16x16x32_bf16 v[192:195], a[64:67], a[48:51], v[192:195]
v_accvgpr_write_b32 a252, v26
v_accvgpr_write_b32 a253, v27
v_mfma_f32_16x16x32_bf16 v[192:195], a[68:71], a[52:55], v[192:195]
v_accvgpr_read_b32 v26, a254
v_accvgpr_read_b32 v27, a255
v_mfma_f32_16x16x32_bf16 v[196:199], a[68:71], a[60:63], v[196:199]
s_add_u32 m0, s38, 0x1000
v_add_f32 v26, v26, v34
v_add_f32 v27, v27, v35
v_mfma_f32_16x16x32_bf16 v[196:199], a[64:67], a[56:59], v[196:199]
s_waitcnt lgkmcnt(0)
v_accvgpr_write_b32 a254, v26
v_accvgpr_write_b32 a255, v27
v_mfma_f32_16x16x32_bf16 v[200:203], a[72:75], a[0:3], v[200:203]
s_mov_b32 s5, s36
s_mov_b32 s36, s37
ds_read_b64_tr_b16 a[64:65], v3 offset:16896
v_mfma_f32_16x16x32_bf16 v[200:203], a[76:79], a[4:7], v[200:203]
buffer_load_dwordx4 v5, s[8:11], s30 offen lds
v_mfma_f32_16x16x32_bf16 v[204:207], a[76:79], a[12:15], v[204:207]
s_mov_b32 s37, s38
s_mov_b32 s38, s5
ds_read_b64_tr_b16 a[66:67], v3 offset:20992
v_mfma_f32_16x16x32_bf16 v[204:207], a[72:75], a[8:11], v[204:207]
s_mov_b32 s5, s39
s_mov_b32 s39, s40
s_mov_b32 s40, s5
v_mfma_f32_16x16x32_bf16 v[208:211], a[72:75], a[16:19], v[208:211]
ds_read_b64_tr_b16 a[68:69], v3 offset:25088
v_mfma_f32_16x16x32_bf16 v[208:211], a[76:79], a[20:23], v[208:211]
v_mfma_f32_16x16x32_bf16 v[212:215], a[76:79], a[28:31], v[212:215]
ds_read_b64_tr_b16 a[70:71], v3 offset:29184
v_mfma_f32_16x16x32_bf16 v[212:215], a[72:75], a[24:27], v[212:215]
buffer_load_dwordx4 v6, s[8:11], s30 offen offset:1024 lds
v_mfma_f32_16x16x32_bf16 v[216:219], a[72:75], a[32:35], v[216:219]
v_mfma_f32_16x16x32_bf16 v[216:219], a[76:79], a[36:39], v[216:219]
v_mfma_f32_16x16x32_bf16 v[220:223], a[76:79], a[44:47], v[220:223]
v_mfma_f32_16x16x32_bf16 v[220:223], a[72:75], a[40:43], v[220:223]
v_mfma_f32_16x16x32_bf16 v[224:227], a[72:75], a[48:51], v[224:227]
buffer_load_dwordx4 v5, s[8:11], s31 offen offset:2048 lds
v_mfma_f32_16x16x32_bf16 v[224:227], a[76:79], a[52:55], v[224:227]
s_cmp_eq_u32 s68, 3
v_mfma_f32_16x16x32_bf16 v[228:231], a[76:79], a[60:63], v[228:231]
s_cbranch_scc1 CAP_T14
v_mfma_f32_16x16x32_bf16 v[228:231], a[72:75], a[56:59], v[228:231]
s_waitcnt lgkmcnt(0)
v_mfma_f32_16x16x32_bf16 a[216:219], a[64:67], a[0:3], a[216:219]
ds_read_b64_tr_b16 a[72:73], v4 offset:16896
v_mfma_f32_16x16x32_bf16 a[216:219], a[68:71], a[4:7], a[216:219]
v_mfma_f32_16x16x32_bf16 a[220:223], a[68:71], a[12:15], a[220:223]
ds_read_b64_tr_b16 a[74:75], v4 offset:20992
v_mfma_f32_16x16x32_bf16 a[220:223], a[64:67], a[8:11], a[220:223]
v_mfma_f32_16x16x32_bf16 v[232:235], a[64:67], a[16:19], v[232:235]
ds_read_b64_tr_b16 a[76:77], v4 offset:25088
v_mfma_f32_16x16x32_bf16 v[232:235], a[68:71], a[20:23], v[232:235]
v_mfma_f32_16x16x32_bf16 v[236:239], a[68:71], a[28:31], v[236:239]
ds_read_b64_tr_b16 a[78:79], v4 offset:29184
v_mfma_f32_16x16x32_bf16 v[236:239], a[64:67], a[24:27], v[236:239]
CB_T14:
v_mfma_f32_16x16x32_bf16 v[240:243], a[64:67], a[32:35], v[240:243]
buffer_load_dwordx4 v6, s[8:11], s31 offen offset:3072 lds
v_mfma_f32_16x16x32_bf16 v[240:243], a[68:71], a[36:39], v[240:243]
v_add_u32 v3, s4, v3
v_add_u32 v4, s4, v4
v_mfma_f32_16x16x32_bf16 v[244:247], a[68:71], a[44:47], v[244:247]
v_mfma_f32_16x16x32_bf16 v[244:247], a[64:67], a[40:43], v[244:247]
v_mfma_f32_16x16x32_bf16 v[248:251], a[64:67], a[48:51], v[248:251]
v_mfma_f32_16x16x32_bf16 v[248:251], a[68:71], a[52:55], v[248:251]
v_mfma_f32_16x16x32_bf16 v[252:255], a[68:71], a[60:63], v[252:255]
v_mfma_f32_16x16x32_bf16 v[252:255], a[64:67], a[56:59], v[252:255]
s_waitcnt vmcnt(8) lgkmcnt(0)
s_barrier
v_mfma_f32_16x16x32_bf16 a[224:227], a[72:75], a[0:3], a[224:227]
s_cmp_eq_u32 s58, 0
ds_read_b128 a[0:3], v1 offset:0
ds_read_b64_tr_b16 a[64:65], v3 offset:0
v_mfma_f32_16x16x32_bf16 a[224:227], a[76:79], a[4:7], a[224:227]
s_cselect_b64 s[12:13], s[20:21], s[16:17]
ds_read_b128 a[4:7], v2 offset:0
v_mfma_f32_16x16x32_bf16 a[228:231], a[76:79], a[12:15], a[228:231]
s_lshl_b32 s73, s58, 2
ds_read_b128 a[12:15], v2 offset:2048
ds_read_b64_tr_b16 a[66:67], v3 offset:4096
v_mfma_f32_16x16x32_bf16 a[228:231], a[72:75], a[8:11], a[228:231]
s_add_u32 s50, s50, s73
ds_read_b128 a[8:11], v1 offset:2048
v_mfma_f32_16x16x32_bf16 a[232:235], a[72:75], a[16:19], a[232:235]
s_mov_b32 s51, s50
ds_read_b128 a[16:19], v1 offset:4096
ds_read_b64_tr_b16 a[68:69], v3 offset:8192
v_mfma_f32_16x16x32_bf16 a[232:235], a[76:79], a[20:23], a[232:235]
s_lshr_b32 s73, s55, 1
ds_read_b128 a[20:23], v2 offset:4096
v_mfma_f32_16x16x32_bf16 a[236:239], a[76:79], a[28:31], a[236:239]
s_mul_i32 s73, s73, s58
ds_read_b128 a[28:31], v2 offset:6144
ds_read_b64_tr_b16 a[70:71], v3 offset:12288
v_mfma_f32_16x16x32_bf16 a[236:239], a[72:75], a[24:27], a[236:239]
s_mul_i32 s7, s73, 12
ds_read_b128 a[24:27], v1 offset:6144
v_mfma_f32_16x16x32_bf16 a[240:243], a[72:75], a[32:35], a[240:243]
s_sub_u32 s52, s45, 256
ds_read_b128 a[32:35], v1 offset:8192
v_mfma_f32_16x16x32_bf16 a[240:243], a[76:79], a[36:39], a[240:243]
s_sub_u32 s91, s91, 1
ds_read_b128 a[36:39], v2 offset:8192
v_xor_b32 v36, s61, v1
v_mfma_f32_16x16x32_bf16 a[244:247], a[76:79], a[44:47], a[244:247]
s_add_u32 s58, s58, 1
ds_read_b128 a[44:47], v2 offset:10240
v_mfma_f32_16x16x32_bf16 a[244:247], a[72:75], a[40:43], a[244:247]
ds_read_b128 a[40:43], v1 offset:10240
v_mfma_f32_16x16x32_bf16 a[248:251], a[72:75], a[48:51], a[248:251]
ds_read_b128 a[48:51], v1 offset:12288
v_mfma_f32_16x16x32_bf16 a[248:251], a[76:79], a[52:55], a[248:251]
ds_read_b128 a[52:55], v2 offset:12288
v_mfma_f32_16x16x32_bf16 a[252:255], a[76:79], a[60:63], a[252:255]
ds_read_b128 a[60:63], v2 offset:14336
v_mfma_f32_16x16x32_bf16 a[252:255], a[72:75], a[56:59], a[252:255]
s_waitcnt lgkmcnt(8)
ds_read_b128 a[56:59], v1 offset:14336
v_mfma_f32_16x16x32_bf16 v[40:43], a[64:67], a[0:3], v[40:43]
s_cmp_eq_u32 s68, 3
ds_read_b64_tr_b16 a[72:73], v4 offset:0
v_mfma_f32_16x16x32_bf16 v[40:43], a[68:71], a[4:7], v[40:43]
s_cbranch_scc1 CAP_T15
v_mfma_f32_16x16x32_bf16 v[44:47], a[68:71], a[12:15], v[44:47]
s_sub_u32 s4, s37, s39
ds_read_b64_tr_b16 a[74:75], v4 offset:4096
v_mfma_f32_16x16x32_bf16 v[44:47], a[64:67], a[8:11], v[44:47]
s_waitcnt lgkmcnt(10)
v_mfma_f32_16x16x32_bf16 v[48:51], a[64:67], a[16:19], v[48:51]
ds_read_b64_tr_b16 a[76:77], v4 offset:8192
v_mfma_f32_16x16x32_bf16 v[48:51], a[68:71], a[20:23], v[48:51]
v_mfma_f32_16x16x32_bf16 v[52:55], a[68:71], a[28:31], v[52:55]
ds_read_b64_tr_b16 a[78:79], v4 offset:12288
v_mfma_f32_16x16x32_bf16 v[52:55], a[64:67], a[24:27], v[52:55]
s_waitcnt lgkmcnt(8)
v_mfma_f32_16x16x32_bf16 v[56:59], a[64:67], a[32:35], v[56:59]
v_mfma_f32_16x16x32_bf16 v[56:59], a[68:71], a[36:39], v[56:59]
v_mfma_f32_16x16x32_bf16 v[60:63], a[68:71], a[44:47], v[60:63]
CB_T15:
v_mfma_f32_16x16x32_bf16 v[60:63], a[64:67], a[40:43], v[60:63]
s_waitcnt lgkmcnt(4)
v_mfma_f32_16x16x32_bf16 v[64:67], a[64:67], a[48:51], v[64:67]
s_lshl_b32 s70, s61, 7
v_mfma_f32_16x16x32_bf16 v[64:67], a[68:71], a[52:55], v[64:67]
s_sub_u32 s70, s38, s70
v_add_u32 v1, s70, v0
v_add_u32 v2, 1024, v1
v_mfma_f32_16x16x32_bf16 v[16:19], a[208:211], a[80:83], 0
v_mfma_f32_16x16x32_bf16 v[20:23], a[212:215], a[80:83], 0
v_mfma_f32_16x16x32_bf16 v[24:27], a[208:211], a[84:87], 0
v_mfma_f32_16x16x32_bf16 v[28:31], a[212:215], a[84:87], 0
v_mfma_f32_16x16x32_bf16 v[68:71], a[68:71], a[60:63], v[68:71]
s_mov_b32 s68, 77
v_mfma_f32_16x16x32_bf16 v[68:71], a[64:67], a[56:59], v[68:71]
s_waitcnt lgkmcnt(0)
v_mfma_f32_16x16x32_bf16 v[72:75], a[72:75], a[0:3], v[72:75]
ds_read_b64_tr_b16 a[64:65], v3 offset:512
v_mfma_f32_16x16x32_bf16 v[72:75], a[76:79], a[4:7], v[72:75]
buffer_load_dwordx2 v[38:39], v12, s[24:27], s69 offen
v_mfma_f32_16x16x32_bf16 v[76:79], a[76:79], a[12:15], v[76:79]
s_add_u32 s69, s69, 2048
ds_read_b64_tr_b16 a[66:67], v3 offset:4608
v_mfma_f32_16x16x32_bf16 v[76:79], a[72:75], a[8:11], v[76:79]
v_mfma_f32_16x16x32_bf16 v[80:83], a[72:75], a[16:19], v[80:83]
ds_read_b64_tr_b16 a[68:69], v3 offset:8704
v_mfma_f32_16x16x32_bf16 v[80:83], a[76:79], a[20:23], v[80:83]
v_mul_f32 v16, v16, v40
v_mul_f32 v17, v17, v41
v_mul_f32 v18, v18, v42
v_mfma_f32_16x16x32_bf16 v[84:87], a[76:79], a[28:31], v[84:87]
ds_read_b64_tr_b16 a[70:71], v3 offset:12800
v_mul_f32 v19, v19, v43
v_mfma_f32_16x16x32_bf16 v[84:87], a[72:75], a[24:27], v[84:87]
v_mul_f32 v20, v20, v72
v_mul_f32 v21, v21, v73
v_mfma_f32_16x16x32_bf16 v[88:91], a[72:75], a[32:35], v[88:91]
s_sub_u32 s6, s38, s60
v_add_u32 v9, s6, v0
v_mul_f32 v22, v22, v74
v_mfma_f32_16x16x32_bf16 v[88:91], a[76:79], a[36:39], v[88:91]
v_mul_f32 v23, v23, v75
v_cvt_pk_bf16_f32 v16, v16, v17
v_mfma_f32_16x16x32_bf16 v[92:95], a[76:79], a[44:47], v[92:95]
v_cvt_pk_bf16_f32 v17, v18, v19
v_cvt_pk_bf16_f32 v18, v20, v21
v_mfma_f32_16x16x32_bf16 v[92:95], a[72:75], a[40:43], v[92:95]
v_cvt_pk_bf16_f32 v19, v22, v23
v_mul_f32 v24, v24, v44
v_mfma_f32_16x16x32_bf16 v[96:99], a[72:75], a[48:51], v[96:99]
buffer_store_dwordx4 v[16:19], v15, s[12:15], 0 offen offset:0 sc1
v_mul_f32 v25, v25, v45
v_mul_f32 v26, v26, v46
v_mul_f32 v27, v27, v47
v_mfma_f32_16x16x32_bf16 v[20:23], a[212:215], a[88:91], 0
ds_write_b128 v9, v[16:19] offset:0
v_mfma_f32_16x16x32_bf16 v[16:19], a[208:211], a[88:91], 0
v_mul_f32 v28, v28, v76
v_mul_f32 v29, v29, v77
v_mul_f32 v30, v30, v78
v_mfma_f32_16x16x32_bf16 v[96:99], a[76:79], a[52:55], v[96:99]
v_mul_f32 v31, v31, v79
v_cvt_pk_bf16_f32 v24, v24, v25
v_mfma_f32_16x16x32_bf16 v[100:103], a[76:79], a[60:63], v[100:103]
v_cvt_pk_bf16_f32 v25, v26, v27
v_cvt_pk_bf16_f32 v26, v28, v29
v_mfma_f32_16x16x32_bf16 v[100:103], a[72:75], a[56:59], v[100:103]
s_waitcnt lgkmcnt(1)
v_cvt_pk_bf16_f32 v27, v30, v31
v_mul_f32 v16, v16, v48
v_mfma_f32_16x16x32_bf16 v[104:107], a[64:67], a[0:3], v[104:107]
buffer_store_dwordx4 v[24:27], v15, s[12:15], s33 offen offset:2048 sc1
ds_read_b64_tr_b16 a[72:73], v4 offset:512
v_mul_f32 v17, v17, v49
v_mul_f32 v18, v18, v50
v_mfma_f32_16x16x32_bf16 v[28:31], a[212:215], a[92:95], 0
ds_write_b128 v9, v[24:27] offset:2048
v_mfma_f32_16x16x32_bf16 v[24:27], a[208:211], a[92:95], 0
v_mul_f32 v19, v19, v51
v_mul_f32 v20, v20, v80
v_mfma_f32_16x16x32_bf16 v[104:107], a[68:71], a[4:7], v[104:107]
v_mul_f32 v21, v21, v81
v_mul_f32 v22, v22, v82
v_mfma_f32_16x16x32_bf16 v[108:111], a[68:71], a[12:15], v[108:111]
ds_read_b64_tr_b16 a[74:75], v4 offset:4608
v_mul_f32 v23, v23, v83
v_mfma_f32_16x16x32_bf16 v[108:111], a[64:67], a[8:11], v[108:111]
v_cvt_pk_bf16_f32 v16, v16, v17
v_cvt_pk_bf16_f32 v17, v18, v19
v_mfma_f32_16x16x32_bf16 v[112:115], a[64:67], a[16:19], v[112:115]
ds_read_b64_tr_b16 a[76:77], v4 offset:8704
v_cvt_pk_bf16_f32 v18, v20, v21
v_mfma_f32_16x16x32_bf16 v[112:115], a[68:71], a[20:23], v[112:115]
v_cvt_pk_bf16_f32 v19, v22, v23
v_mul_f32 v24, v24, v52
v_mfma_f32_16x16x32_bf16 v[116:119], a[68:71], a[28:31], v[116:119]
buffer_store_dwordx4 v[16:19], v15, s[12:15], s34 offen offset:0 sc1
ds_read_b64_tr_b16 a[78:79], v4 offset:12800
v_mul_f32 v25, v25, v53
v_mul_f32 v26, v26, v54
v_mfma_f32_16x16x32_bf16 v[20:23], a[212:215], a[96:99], 0
ds_write_b128 v9, v[16:19] offset:4096
v_mfma_f32_16x16x32_bf16 v[16:19], a[208:211], a[96:99], 0
v_mul_f32 v27, v27, v55
v_mul_f32 v28, v28, v84
v_mfma_f32_16x16x32_bf16 v[116:119], a[64:67], a[24:27], v[116:119]
v_mul_f32 v29, v29, v85
v_mul_f32 v30, v30, v86
v_mfma_f32_16x16x32_bf16 v[120:123], a[64:67], a[32:35], v[120:123]
v_mul_f32 v31, v31, v87
v_cvt_pk_bf16_f32 v24, v24, v25
v_mfma_f32_16x16x32_bf16 v[120:123], a[68:71], a[36:39], v[120:123]
v_cvt_pk_bf16_f32 v25, v26, v27
v_cvt_pk_bf16_f32 v26, v28, v29
v_mfma_f32_16x16x32_bf16 v[124:127], a[68:71], a[44:47], v[124:127]
v_cvt_pk_bf16_f32 v27, v30, v31
v_mul_f32 v16, v16, v56
v_mfma_f32_16x16x32_bf16 v[124:127], a[64:67], a[40:43], v[124:127]
buffer_store_dwordx4 v[24:27], v15, s[12:15], s35 offen offset:2048 sc1
v_mul_f32 v17, v17, v57
v_mul_f32 v18, v18, v58
v_mul_f32 v19, v19, v59
v_mfma_f32_16x16x32_bf16 v[28:31], a[212:215], a[100:103], 0
ds_write_b128 v9, v[24:27] offset:6144
v_mfma_f32_16x16x32_bf16 v[24:27], a[208:211], a[100:103], 0
v_mul_f32 v20, v20, v88
v_mul_f32 v21, v21, v89
v_mfma_f32_16x16x32_bf16 v[128:131], a[64:67], a[48:51], v[128:131]
v_mul_f32 v22, v22, v90
v_mul_f32 v23, v23, v91
v_mfma_f32_16x16x32_bf16 v[128:131], a[68:71], a[52:55], v[128:131]
v_cvt_pk_bf16_f32 v16, v16, v17
v_cvt_pk_bf16_f32 v17, v18, v19
v_mfma_f32_16x16x32_bf16 v[132:135], a[68:71], a[60:63], v[132:135]
v_cvt_pk_bf16_f32 v18, v20, v21
v_cvt_pk_bf16_f32 v19, v22, v23
v_mfma_f32_16x16x32_bf16 v[132:135], a[64:67], a[56:59], v[132:135]
s_waitcnt lgkmcnt(2)
buffer_store_dwordx4 v[16:19], v15, s[12:15], s62 offen offset:0 sc1
v_mul_f32 v24, v24, v60
v_mul_f32 v25, v25, v61
v_mul_f32 v26, v26, v62
v_mfma_f32_16x16x32_bf16 v[136:139], a[72:75], a[0:3], v[136:139]
ds_read_b64_tr_b16 a[64:65], v3 offset:16384
v_mul_f32 v27, v27, v63
v_mfma_f32_16x16x32_bf16 v[20:23], a[212:215], a[104:107], 0
ds_write_b128 v9, v[16:19] offset:8192
v_mfma_f32_16x16x32_bf16 v[16:19], a[208:211], a[104:107], 0
v_mul_f32 v28, v28, v92
v_mul_f32 v29, v29, v93
v_mul_f32 v30, v30, v94
v_mfma_f32_16x16x32_bf16 v[136:139], a[76:79], a[4:7], v[136:139]
v_mul_f32 v31, v31, v95
v_cvt_pk_bf16_f32 v24, v24, v25
v_mfma_f32_16x16x32_bf16 v[140:143], a[76:79], a[12:15], v[140:143]
ds_read_b64_tr_b16 a[66:67], v3 offset:20480
v_cvt_pk_bf16_f32 v25, v26, v27
v_mfma_f32_16x16x32_bf16 v[140:143], a[72:75], a[8:11], v[140:143]
v_cvt_pk_bf16_f32 v26, v28, v29
v_cvt_pk_bf16_f32 v27, v30, v31
v_mfma_f32_16x16x32_bf16 v[144:147], a[72:75], a[16:19], v[144:147]
buffer_store_dwordx4 v[24:27], v15, s[12:15], s63 offen offset:0 sc1
ds_read_b64_tr_b16 a[68:69], v3 offset:24576
v_mul_f32 v16, v16, v64
v_mul_f32 v17, v17, v65
v_mfma_f32_16x16x32_bf16 v[28:31], a[212:215], a[108:111], 0
ds_write_b128 v9, v[24:27] offset:10240
v_mfma_f32_16x16x32_bf16 v[24:27], a[208:211], a[108:111], 0
v_mul_f32 v18, v18, v66
v_mul_f32 v19, v19, v67
v_mfma_f32_16x16x32_bf16 v[144:147], a[76:79], a[20:23], v[144:147]
v_mul_f32 v20, v20, v96
v_mul_f32 v21, v21, v97
v_mfma_f32_16x16x32_bf16 v[148:151], a[76:79], a[28:31], v[148:151]
ds_read_b64_tr_b16 a[70:71], v3 offset:28672
v_mul_f32 v22, v22, v98
v_mfma_f32_16x16x32_bf16 v[148:151], a[72:75], a[24:27], v[148:151]
v_mul_f32 v23, v23, v99
v_cvt_pk_bf16_f32 v16, v16, v17
v_mfma_f32_16x16x32_bf16 v[152:155], a[72:75], a[32:35], v[152:155]
v_cvt_pk_bf16_f32 v17, v18, v19
v_cvt_pk_bf16_f32 v18, v20, v21
v_mfma_f32_16x16x32_bf16 v[152:155], a[76:79], a[36:39], v[152:155]
v_cvt_pk_bf16_f32 v19, v22, v23
v_mul_f32 v24, v24, v68
v_mfma_f32_16x16x32_bf16 v[156:159], a[76:79], a[44:47], v[156:159]
buffer_store_dwordx4 v[16:19], v15, s[12:15], s64 offen offset:0 sc1
v_mul_f32 v25, v25, v69
v_mul_f32 v26, v26, v70
v_mul_f32 v27, v27, v71
v_mfma_f32_16x16x32_bf16 v[20:23], a[212:215], a[112:115], 0
ds_write_b128 v9, v[16:19] offset:12288
v_mfma_f32_16x16x32_bf16 v[16:19], a[208:211], a[112:115], 0
v_mul_f32 v28, v28, v100
v_mul_f32 v29, v29, v101
v_mfma_f32_16x16x32_bf16 v[156:159], a[72:75], a[40:43], v[156:159]
v_mul_f32 v30, v30, v102
v_mul_f32 v31, v31, v103
v_mfma_f32_16x16x32_bf16 v[160:163], a[72:75], a[48:51], v[160:163]
s_add_u32 s41, s41, 1
v_cvt_pk_bf16_f32 v24, v24, v25
v_cvt_pk_bf16_f32 v25, v26, v27
v_mfma_f32_16x16x32_bf16 v[160:163], a[76:79], a[52:55], v[160:163]
v_cvt_pk_bf16_f32 v26, v28, v29
v_cvt_pk_bf16_f32 v27, v30, v31
v_mfma_f32_16x16x32_bf16 v[164:167], a[76:79], a[60:63], v[164:167]
buffer_store_dwordx4 v[24:27], v15, s[12:15], s101 offen offset:0 sc1
v_mul_f32 v16, v16, v104
v_mul_f32 v17, v17, v105
v_mul_f32 v18, v18, v106
v_mfma_f32_16x16x32_bf16 v[28:31], a[212:215], a[116:119], 0
ds_write_b128 v9, v[24:27] offset:14336
v_mfma_f32_16x16x32_bf16 v[24:27], a[208:211], a[116:119], 0
v_mul_f32 v19, v19, v107
v_mul_f32 v20, v20, v136
v_mfma_f32_16x16x32_bf16 v[164:167], a[72:75], a[56:59], v[164:167]
s_waitcnt lgkmcnt(2)
v_mul_f32 v21, v21, v137
v_mfma_f32_16x16x32_bf16 v[168:171], a[64:67], a[0:3], v[168:171]
s_sub_u32 s6, s40, s60
ds_read_b64_tr_b16 a[72:73], v4 offset:16384
v_add_u32 v9, s6, v0
v_mul_f32 v22, v22, v138
v_mfma_f32_16x16x32_bf16 v[168:171], a[68:71], a[4:7], v[168:171]
v_mul_f32 v23, v23, v139
v_cvt_pk_bf16_f32 v16, v16, v17
v_mfma_f32_16x16x32_bf16 v[172:175], a[68:71], a[12:15], v[172:175]
ds_read_b64_tr_b16 a[74:75], v4 offset:20480
v_cvt_pk_bf16_f32 v17, v18, v19
v_mfma_f32_16x16x32_bf16 v[172:175], a[64:67], a[8:11], v[172:175]
v_cvt_pk_bf16_f32 v18, v20, v21
v_cvt_pk_bf16_f32 v19, v22, v23
v_mfma_f32_16x16x32_bf16 v[176:179], a[64:67], a[16:19], v[176:179]
ds_read_b64_tr_b16 a[76:77], v4 offset:24576
v_mul_f32 v24, v24, v108
v_mfma_f32_16x16x32_bf16 v[20:23], a[212:215], a[120:123], 0
ds_write_b128 v9, v[16:19] offset:0
v_mfma_f32_16x16x32_bf16 v[16:19], a[208:211], a[120:123], 0
v_mul_f32 v25, v25, v109
v_mul_f32 v26, v26, v110
v_mfma_f32_16x16x32_bf16 v[176:179], a[68:71], a[20:23], v[176:179]
v_mul_f32 v27, v27, v111
v_mul_f32 v28, v28, v140
v_mfma_f32_16x16x32_bf16 v[180:183], a[68:71], a[28:31], v[180:183]
ds_read_b64_tr_b16 a[78:79], v4 offset:28672
v_mul_f32 v29, v29, v141
v_mfma_f32_16x16x32_bf16 v[180:183], a[64:67], a[24:27], v[180:183]
v_mul_f32 v30, v30, v142
v_mul_f32 v31, v31, v143
v_mfma_f32_16x16x32_bf16 v[184:187], a[64:67], a[32:35], v[184:187]
v_cvt_pk_bf16_f32 v24, v24, v25
v_cvt_pk_bf16_f32 v25, v26, v27
v_mfma_f32_16x16x32_bf16 v[184:187], a[68:71], a[36:39], v[184:187]
v_cvt_pk_bf16_f32 v26, v28, v29
v_cvt_pk_bf16_f32 v27, v30, v31
v_mfma_f32_16x16x32_bf16 v[28:31], a[212:215], a[124:127], 0
ds_write_b128 v9, v[24:27] offset:2048
v_mfma_f32_16x16x32_bf16 v[24:27], a[208:211], a[124:127], 0
v_mul_f32 v16, v16, v112
v_mul_f32 v17, v17, v113
v_mfma_f32_16x16x32_bf16 v[188:191], a[68:71], a[44:47], v[188:191]
v_mul_f32 v18, v18, v114
v_mul_f32 v19, v19, v115
v_mfma_f32_16x16x32_bf16 v[188:191], a[64:67], a[40:43], v[188:191]
v_mul_f32 v20, v20, v144
v_mul_f32 v21, v21, v145
v_mfma_f32_16x16x32_bf16 v[192:195], a[64:67], a[48:51], v[192:195]
v_mul_f32 v22, v22, v146
v_mul_f32 v23, v23, v147
v_mfma_f32_16x16x32_bf16 v[192:195], a[68:71], a[52:55], v[192:195]
v_cvt_pk_bf16_f32 v16, v16, v17
v_cvt_pk_bf16_f32 v17, v18, v19
v_mfma_f32_16x16x32_bf16 v[196:199], a[68:71], a[60:63], v[196:199]
v_cvt_pk_bf16_f32 v18, v20, v21
v_cvt_pk_bf16_f32 v19, v22, v23
v_mfma_f32_16x16x32_bf16 v[196:199], a[64:67], a[56:59], v[196:199]
s_waitcnt lgkmcnt(1)
buffer_store_dwordx4 v[16:19], v15, s[12:15], s34 offen offset:128 sc1
v_mul_f32 v24, v24, v116
v_mul_f32 v25, v25, v117
v_mul_f32 v26, v26, v118
v_mfma_f32_16x16x32_bf16 v[200:203], a[72:75], a[0:3], v[200:203]
ds_read_b64_tr_b16 a[64:65], v3 offset:16896
v_mul_f32 v27, v27, v119
v_mfma_f32_16x16x32_bf16 v[20:23], a[212:215], a[128:131], 0
ds_write_b128 v9, v[16:19] offset:4096
v_mfma_f32_16x16x32_bf16 v[16:19], a[208:211], a[128:131], 0
v_mul_f32 v28, v28, v148
v_mul_f32 v29, v29, v149
v_mfma_f32_16x16x32_bf16 v[200:203], a[76:79], a[4:7], v[200:203]
v_mul_f32 v30, v30, v150
v_mul_f32 v31, v31, v151
v_mfma_f32_16x16x32_bf16 v[204:207], a[76:79], a[12:15], v[204:207]
ds_read_b64_tr_b16 a[66:67], v3 offset:20992
v_cvt_pk_bf16_f32 v24, v24, v25
v_cvt_pk_bf16_f32 v25, v26, v27
v_mfma_f32_16x16x32_bf16 v[204:207], a[72:75], a[8:11], v[204:207]
v_cvt_pk_bf16_f32 v26, v28, v29
v_cvt_pk_bf16_f32 v27, v30, v31
v_mfma_f32_16x16x32_bf16 v[208:211], a[72:75], a[16:19], v[208:211]
ds_read_b64_tr_b16 a[68:69], v3 offset:25088
v_mul_f32 v16, v16, v120
v_mfma_f32_16x16x32_bf16 v[28:31], a[212:215], a[132:135], 0
ds_write_b128 v9, v[24:27] offset:6144
v_mfma_f32_16x16x32_bf16 v[24:27], a[208:211], a[132:135], 0
v_mul_f32 v17, v17, v121
v_mul_f32 v18, v18, v122
v_mfma_f32_16x16x32_bf16 v[208:211], a[76:79], a[20:23], v[208:211]
v_mul_f32 v19, v19, v123
v_mul_f32 v20, v20, v152
v_mfma_f32_16x16x32_bf16 v[212:215], a[76:79], a[28:31], v[212:215]
ds_read_b64_tr_b16 a[70:71], v3 offset:29184
v_mul_f32 v21, v21, v153
v_mfma_f32_16x16x32_bf16 v[212:215], a[72:75], a[24:27], v[212:215]
v_mul_f32 v22, v22, v154
v_mul_f32 v23, v23, v155
v_mfma_f32_16x16x32_bf16 v[216:219], a[72:75], a[32:35], v[216:219]
v_cvt_pk_bf16_f32 v16, v16, v17
v_cvt_pk_bf16_f32 v17, v18, v19
v_mfma_f32_16x16x32_bf16 v[216:219], a[76:79], a[36:39], v[216:219]
v_cvt_pk_bf16_f32 v18, v20, v21
v_cvt_pk_bf16_f32 v19, v22, v23
v_mfma_f32_16x16x32_bf16 v[20:23], a[212:215], a[136:139], 0
ds_write_b128 v9, v[16:19] offset:8192
v_mfma_f32_16x16x32_bf16 v[16:19], a[208:211], a[136:139], 0
v_mul_f32 v24, v24, v124
v_mul_f32 v25, v25, v125
v_mfma_f32_16x16x32_bf16 v[220:223], a[76:79], a[44:47], v[220:223]
v_mul_f32 v26, v26, v126
v_mul_f32 v27, v27, v127
v_mfma_f32_16x16x32_bf16 v[220:223], a[72:75], a[40:43], v[220:223]
v_mul_f32 v28, v28, v156
v_mul_f32 v29, v29, v157
v_mfma_f32_16x16x32_bf16 v[224:227], a[72:75], a[48:51], v[224:227]
s_mov_b32 s76, s36
v_mul_f32 v30, v30, v158
v_mul_f32 v31, v31, v159
v_mfma_f32_16x16x32_bf16 v[224:227], a[76:79], a[52:55], v[224:227]
s_mov_b32 s77, s39
v_cvt_pk_bf16_f32 v24, v24, v25
v_cvt_pk_bf16_f32 v25, v26, v27
v_mfma_f32_16x16x32_bf16 v[228:231], a[76:79], a[60:63], v[228:231]
s_mov_b32 s39, s37
v_cvt_pk_bf16_f32 v26, v28, v29
v_cvt_pk_bf16_f32 v27, v30, v31
v_mfma_f32_16x16x32_bf16 v[228:231], a[72:75], a[56:59], v[228:231]
s_waitcnt lgkmcnt(1)
buffer_store_dwordx4 v[24:27], v15, s[12:15], s63 offen offset:128 sc1
v_mul_f32 v16, v16, v128
v_mul_f32 v17, v17, v129
v_mul_f32 v18, v18, v130
v_mfma_f32_16x16x32_bf16 a[216:219], a[64:67], a[0:3], a[216:219]
s_mov_b32 s37, s40
ds_read_b64_tr_b16 a[72:73], v4 offset:16896
v_mul_f32 v19, v19, v131
v_mfma_f32_16x16x32_bf16 v[28:31], a[212:215], a[140:143], 0
HOP3:
s_cbranch_execz HOP7
ds_write_b128 v9, v[24:27] offset:10240
v_mfma_f32_16x16x32_bf16 v[24:27], a[208:211], a[140:143], 0
v_mul_f32 v20, v20, v160
v_mul_f32 v21, v21, v161
v_mfma_f32_16x16x32_bf16 a[216:219], a[68:71], a[4:7], a[216:219]
s_mov_b32 s36, s38
v_mul_f32 v22, v22, v162
v_mul_f32 v23, v23, v163
v_mfma_f32_16x16x32_bf16 a[220:223], a[68:71], a[12:15], a[220:223]
s_mov_b32 s40, s38
ds_read_b64_tr_b16 a[74:75], v4 offset:20992
v_cvt_pk_bf16_f32 v16, v16, v17
v_mfma_f32_16x16x32_bf16 a[220:223], a[64:67], a[8:11], a[220:223]
v_cvt_pk_bf16_f32 v17, v18, v19
v_cvt_pk_bf16_f32 v18, v20, v21
v_mfma_f32_16x16x32_bf16 v[232:235], a[64:67], a[16:19], v[232:235]
ds_read_b64_tr_b16 a[76:77], v4 offset:25088
v_cvt_pk_bf16_f32 v19, v22, v23
v_mfma_f32_16x16x32_bf16 v[20:23], a[212:215], a[144:147], 0
ds_write_b128 v9, v[16:19] offset:12288
v_mfma_f32_16x16x32_bf16 v[16:19], a[208:211], a[144:147], 0
v_mul_f32 v24, v24, v132
v_mul_f32 v25, v25, v133
v_mul_f32 v26, v26, v134
v_mfma_f32_16x16x32_bf16 v[232:235], a[68:71], a[20:23], v[232:235]
v_mul_f32 v27, v27, v135
v_mul_f32 v28, v28, v164
v_mfma_f32_16x16x32_bf16 v[236:239], a[68:71], a[28:31], v[236:239]
ds_read_b64_tr_b16 a[78:79], v4 offset:29184
v_mul_f32 v29, v29, v165
v_mfma_f32_16x16x32_bf16 v[236:239], a[64:67], a[24:27], v[236:239]
v_mul_f32 v30, v30, v166
v_mul_f32 v31, v31, v167
v_mfma_f32_16x16x32_bf16 v[240:243], a[64:67], a[32:35], v[240:243]
v_add_u32 v3, s4, v3
v_add_u32 v4, s4, v4
v_mfma_f32_16x16x32_bf16 v[240:243], a[68:71], a[36:39], v[240:243]
v_cvt_pk_bf16_f32 v24, v24, v25
v_cvt_pk_bf16_f32 v25, v26, v27
v_mfma_f32_16x16x32_bf16 v[244:247], a[68:71], a[44:47], v[244:247]
v_cvt_pk_bf16_f32 v26, v28, v29
v_cvt_pk_bf16_f32 v27, v30, v31
v_mfma_f32_16x16x32_bf16 v[244:247], a[64:67], a[40:43], v[244:247]
buffer_store_dwordx4 v[24:27], v15, s[12:15], s101 offen offset:128 sc1
v_mul_f32 v16, v16, v168
v_mul_f32 v17, v17, v169
v_mul_f32 v18, v18, v170
v_mfma_f32_16x16x32_bf16 v[28:31], a[212:215], a[148:151], 0
ds_write_b128 v9, v[24:27] offset:14336
v_mfma_f32_16x16x32_bf16 v[24:27], a[208:211], a[148:151], 0
v_mul_f32 v19, v19, v171
v_mul_f32 v20, v20, v200
v_mfma_f32_16x16x32_bf16 v[248:251], a[64:67], a[48:51], v[248:251]
v_mul_f32 v21, v21, v201
v_mul_f32 v22, v22, v202
v_mfma_f32_16x16x32_bf16 v[248:251], a[68:71], a[52:55], v[248:251]
v_mul_f32 v23, v23, v203
v_cvt_pk_bf16_f32 v16, v16, v17
v_mfma_f32_16x16x32_bf16 v[252:255], a[68:71], a[60:63], v[252:255]
v_cvt_pk_bf16_f32 v17, v18, v19
v_cvt_pk_bf16_f32 v18, v20, v21
v_mfma_f32_16x16x32_bf16 v[252:255], a[64:67], a[56:59], v[252:255]
s_waitcnt vmcnt(12) lgkmcnt(0)
s_barrier
v_mfma_f32_16x16x32_bf16 a[224:227], a[72:75], a[0:3], a[224:227]
ds_read_b64_tr_b16 a[64:65], v3 offset:0
v_cvt_pk_bf16_f32 v19, v22, v23
v_mfma_f32_16x16x32_bf16 a[224:227], a[76:79], a[4:7], a[224:227]
s_sub_u32 s6, s76, s60
ds_read_b64_tr_b16 a[66:67], v3 offset:4096
v_add_u32 v9, s6, v0
v_mfma_f32_16x16x32_bf16 v[20:23], a[212:215], a[152:155], 0
ds_write_b128 v9, v[16:19] offset:0
v_mfma_f32_16x16x32_bf16 v[16:19], a[208:211], a[152:155], 0
v_mul_f32 v24, v24, v172
v_mul_f32 v25, v25, v173
v_mfma_f32_16x16x32_bf16 a[228:231], a[76:79], a[12:15], a[228:231]
ds_read_b64_tr_b16 a[68:69], v3 offset:8192
v_mul_f32 v26, v26, v174
v_mul_f32 v27, v27, v175
v_mfma_f32_16x16x32_bf16 a[228:231], a[72:75], a[8:11], a[228:231]
ds_read_b128 a[0:3], v1 offset:0
v_mul_f32 v28, v28, v204
v_mfma_f32_16x16x32_bf16 a[232:235], a[72:75], a[16:19], a[232:235]
ds_read_b128 a[4:7], v2 offset:0
v_mul_f32 v29, v29, v205
v_mfma_f32_16x16x32_bf16 a[232:235], a[76:79], a[20:23], a[232:235]
ds_read_b128 a[12:15], v2 offset:2048
v_mul_f32 v30, v30, v206
v_mfma_f32_16x16x32_bf16 a[236:239], a[76:79], a[28:31], a[236:239]
ds_read_b128 a[8:11], v1 offset:2048
v_mul_f32 v31, v31, v207
v_mfma_f32_16x16x32_bf16 a[236:239], a[72:75], a[24:27], a[236:239]
ds_read_b128 a[16:19], v1 offset:4096
v_cvt_pk_bf16_f32 v24, v24, v25
v_mfma_f32_16x16x32_bf16 a[240:243], a[72:75], a[32:35], a[240:243]
ds_read_b64_tr_b16 a[70:71], v3 offset:12288
v_cvt_pk_bf16_f32 v25, v26, v27
v_mfma_f32_16x16x32_bf16 a[240:243], a[76:79], a[36:39], a[240:243]
ds_read_b128 a[20:23], v2 offset:4096
v_cvt_pk_bf16_f32 v26, v28, v29
v_mfma_f32_16x16x32_bf16 a[244:247], a[76:79], a[44:47], a[244:247]
ds_read_b128 a[28:31], v2 offset:6144
v_cvt_pk_bf16_f32 v27, v30, v31
v_mfma_f32_16x16x32_bf16 a[244:247], a[72:75], a[40:43], a[244:247]
buffer_store_dwordx4 v[24:27], v15, s[12:15], s33 offen offset:2304 sc1
ds_read_b128 a[24:27], v1 offset:6144
v_mul_f32 v16, v16, v176
v_mul_f32 v17, v17, v177
v_mfma_f32_16x16x32_bf16 v[28:31], a[212:215], a[156:159], 0
ds_write_b128 v9, v[24:27] offset:2048
v_mfma_f32_16x16x32_bf16 v[24:27], a[208:211], a[156:159], 0
v_mul_f32 v18, v18, v178
v_mul_f32 v19, v19, v179
v_mul_f32 v20, v20, v208
v_mfma_f32_16x16x32_bf16 a[248:251], a[72:75], a[48:51], a[248:251]
ds_read_b128 a[32:35], v1 offset:8192
v_mul_f32 v21, v21, v209
v_mfma_f32_16x16x32_bf16 a[248:251], a[76:79], a[52:55], a[248:251]
ds_read_b128 a[36:39], v2 offset:8192
v_mul_f32 v22, v22, v210
v_mfma_f32_16x16x32_bf16 a[252:255], a[76:79], a[60:63], a[252:255]
v_mul_f32 v23, v23, v211
v_cvt_pk_bf16_f32 v16, v16, v17
v_mfma_f32_16x16x32_bf16 a[252:255], a[72:75], a[56:59], a[252:255]
s_waitcnt lgkmcnt(6)
ds_read_b128 a[44:47], v2 offset:10240
v_cvt_pk_bf16_f32 v17, v18, v19
v_mfma_f32_16x16x32_bf16 v[40:43], a[64:67], a[0:3], v[40:43]
ds_read_b128 a[40:43], v1 offset:10240
v_cvt_pk_bf16_f32 v18, v20, v21
v_mfma_f32_16x16x32_bf16 v[40:43], a[68:71], a[4:7], v[40:43]
s_lshl_b32 s70, s41, 17
ds_read_b128 a[48:51], v1 offset:12288
v_cvt_pk_bf16_f32 v19, v22, v23
v_mfma_f32_16x16x32_bf16 v[20:23], a[212:215], a[160:163], 0
ds_write_b128 v9, v[16:19] offset:4096
v_mfma_f32_16x16x32_bf16 v[16:19], a[208:211], a[160:163], 0
v_mul_f32 v24, v24, v180
v_mul_f32 v25, v25, v181
v_mul_f32 v26, v26, v182
v_mfma_f32_16x16x32_bf16 v[44:47], a[68:71], a[12:15], v[44:47]
s_add_u32 s70, s70, s45
ds_read_b128 a[52:55], v2 offset:12288
v_mul_f32 v27, v27, v183
v_mfma_f32_16x16x32_bf16 v[44:47], a[64:67], a[8:11], v[44:47]
s_waitcnt lgkmcnt(8)
ds_read_b128 a[60:63], v2 offset:14336
v_mul_f32 v28, v28, v212
v_mfma_f32_16x16x32_bf16 v[48:51], a[64:67], a[16:19], v[48:51]
s_sub_u32 s71, s70, s44
ds_read_b64_tr_b16 a[72:73], v4 offset:0
v_mul_f32 v29, v29, v213
v_mfma_f32_16x16x32_bf16 v[48:51], a[68:71], a[20:23], v[48:51]
s_mov_b32 s44, s70
ds_read_b128 a[56:59], v1 offset:14336
v_add_u32 v5, s71, v5
v_mfma_f32_16x16x32_bf16 v[52:55], a[68:71], a[28:31], v[52:55]
s_sub_u32 s79, s37, s36
ds_read_b64_tr_b16 a[74:75], v4 offset:4096
v_add_u32 v6, s71, v6
v_mfma_f32_16x16x32_bf16 v[52:55], a[64:67], a[24:27], v[52:55]
s_waitcnt lgkmcnt(9)
ds_read_b64_tr_b16 a[76:77], v4 offset:8192
v_add_u32 v1, s79, v1
v_mfma_f32_16x16x32_bf16 v[56:59], a[64:67], a[32:35], v[56:59]
s_sub_u32 s4, s40, s39
ds_read_b64_tr_b16 a[78:79], v4 offset:12288
v_add_u32 v2, s79, v2
v_mfma_f32_16x16x32_bf16 v[56:59], a[68:71], a[36:39], v[56:59]
s_waitcnt lgkmcnt(9)
v_mul_f32 v30, v30, v214
v_mul_f32 v31, v31, v215
v_cvt_pk_bf16_f32 v24, v24, v25
v_mfma_f32_16x16x32_bf16 v[60:63], a[68:71], a[44:47], v[60:63]
v_cvt_pk_bf16_f32 v25, v26, v27
v_cvt_pk_bf16_f32 v26, v28, v29
v_mfma_f32_16x16x32_bf16 v[60:63], a[64:67], a[40:43], v[60:63]
s_waitcnt lgkmcnt(6)
v_cvt_pk_bf16_f32 v27, v30, v31
v_mul_f32 v16, v16, v184
v_mfma_f32_16x16x32_bf16 v[64:67], a[64:67], a[48:51], v[64:67]
buffer_store_dwordx4 v[24:27], v15, s[12:15], s35 offen offset:2304 sc1
v_mul_f32 v17, v17, v185
v_mul_f32 v18, v18, v186
v_mul_f32 v19, v19, v187
v_mfma_f32_16x16x32_bf16 v[28:31], a[212:215], a[164:167], 0
ds_write_b128 v9, v[24:27] offset:6144
v_mfma_f32_16x16x32_bf16 v[24:27], a[208:211], a[164:167], 0
v_mul_f32 v20, v20, v216
v_mul_f32 v21, v21, v217
v_mfma_f32_16x16x32_bf16 v[64:67], a[68:71], a[52:55], v[64:67]
s_waitcnt lgkmcnt(4)
v_mul_f32 v22, v22, v218
v_mul_f32 v23, v23, v219
v_mfma_f32_16x16x32_bf16 v[68:71], a[68:71], a[60:63], v[68:71]
s_barrier
v_cvt_pk_bf16_f32 v16, v16, v17
v_cvt_pk_bf16_f32 v17, v18, v19
v_mfma_f32_16x16x32_bf16 v[68:71], a[64:67], a[56:59], v[68:71]
s_waitcnt lgkmcnt(1)
v_cvt_pk_bf16_f32 v18, v20, v21
v_cvt_pk_bf16_f32 v19, v22, v23
v_mfma_f32_16x16x32_bf16 v[72:75], a[72:75], a[0:3], v[72:75]
s_mov_b32 m0, s40
ds_read_b64_tr_b16 a[64:65], v3 offset:512
v_mul_f32 v24, v24, v188
v_mfma_f32_16x16x32_bf16 v[20:23], a[212:215], a[168:171], 0
ds_write_b128 v9, v[16:19] offset:8192
v_mfma_f32_16x16x32_bf16 v[16:19], a[208:211], a[168:171], 0
v_mul_f32 v25, v25, v189
v_mul_f32 v26, v26, v190
v_mul_f32 v27, v27, v191
v_mfma_f32_16x16x32_bf16 v[72:75], a[76:79], a[4:7], v[72:75]
buffer_load_dwordx4 v5, s[8:11], 0 offen lds
v_mfma_f32_16x16x32_bf16 v[76:79], a[76:79], a[12:15], v[76:79]
ds_read_b64_tr_b16 a[66:67], v3 offset:4608
v_mul_f32 v28, v28, v220
v_mfma_f32_16x16x32_bf16 v[76:79], a[72:75], a[8:11], v[76:79]
v_mul_f32 v29, v29, v221
v_mul_f32 v30, v30, v222
v_mfma_f32_16x16x32_bf16 v[80:83], a[72:75], a[16:19], v[80:83]
ds_read_b64_tr_b16 a[68:69], v3 offset:8704
v_mul_f32 v31, v31, v223
v_mfma_f32_16x16x32_bf16 v[80:83], a[76:79], a[20:23], v[80:83]
buffer_load_dwordx4 v6, s[8:11], 0 offen offset:1024 lds
v_mfma_f32_16x16x32_bf16 v[84:87], a[76:79], a[28:31], v[84:87]
ds_read_b64_tr_b16 a[70:71], v3 offset:12800
v_cvt_pk_bf16_f32 v24, v24, v25
v_mfma_f32_16x16x32_bf16 v[84:87], a[72:75], a[24:27], v[84:87]
v_cvt_pk_bf16_f32 v25, v26, v27
v_cvt_pk_bf16_f32 v26, v28, v29
v_cvt_pk_bf16_f32 v27, v30, v31
v_mfma_f32_16x16x32_bf16 v[88:91], a[72:75], a[32:35], v[88:91]
buffer_store_dwordx4 v[24:27], v15, s[12:15], s63 offen offset:256 sc1
v_mul_f32 v16, v16, v192
v_mul_f32 v17, v17, v193
v_mul_f32 v18, v18, v194
v_mfma_f32_16x16x32_bf16 v[28:31], a[212:215], a[172:175], 0
ds_write_b128 v9, v[24:27] offset:10240
v_mfma_f32_16x16x32_bf16 v[24:27], a[208:211], a[172:175], 0
v_mul_f32 v19, v19, v195
v_mul_f32 v20, v20, v224
v_mfma_f32_16x16x32_bf16 v[88:91], a[76:79], a[36:39], v[88:91]
buffer_load_dwordx4 v5, s[8:11], s29 offen offset:2048 lds
v_mfma_f32_16x16x32_bf16 v[92:95], a[76:79], a[44:47], v[92:95]
v_mul_f32 v21, v21, v225
v_mul_f32 v22, v22, v226
v_mfma_f32_16x16x32_bf16 v[92:95], a[72:75], a[40:43], v[92:95]
v_mul_f32 v23, v23, v227
v_cvt_pk_bf16_f32 v16, v16, v17
v_mfma_f32_16x16x32_bf16 v[96:99], a[72:75], a[48:51], v[96:99]
v_cvt_pk_bf16_f32 v17, v18, v19
v_cvt_pk_bf16_f32 v18, v20, v21
v_mfma_f32_16x16x32_bf16 v[96:99], a[76:79], a[52:55], v[96:99]
v_cvt_pk_bf16_f32 v19, v22, v23
v_mul_f32 v24, v24, v196
v_mfma_f32_16x16x32_bf16 v[20:23], a[212:215], a[176:179], 0
ds_write_b128 v9, v[16:19] offset:12288
v_mfma_f32_16x16x32_bf16 v[16:19], a[208:211], a[176:179], 0
v_mul_f32 v25, v25, v197
v_mul_f32 v26, v26, v198
v_mul_f32 v27, v27, v199
v_mfma_f32_16x16x32_bf16 v[100:103], a[76:79], a[60:63], v[100:103]
buffer_load_dwordx4 v6, s[8:11], s29 offen offset:3072 lds
v_mfma_f32_16x16x32_bf16 v[100:103], a[72:75], a[56:59], v[100:103]
s_waitcnt lgkmcnt(2)
v_mul_f32 v28, v28, v228
v_mul_f32 v29, v29, v229
v_mfma_f32_16x16x32_bf16 v[104:107], a[64:67], a[0:3], v[104:107]
ds_read_b64_tr_b16 a[72:73], v4 offset:512
v_mul_f32 v30, v30, v230
v_mfma_f32_16x16x32_bf16 v[104:107], a[68:71], a[4:7], v[104:107]
s_add_u32 m0, s40, 0x1000
v_mul_f32 v31, v31, v231
v_cvt_pk_bf16_f32 v24, v24, v25
v_mfma_f32_16x16x32_bf16 v[108:111], a[68:71], a[12:15], v[108:111]
ds_read_b64_tr_b16 a[74:75], v4 offset:4608
v_cvt_pk_bf16_f32 v25, v26, v27
v_mfma_f32_16x16x32_bf16 v[108:111], a[64:67], a[8:11], v[108:111]
buffer_load_dwordx4 v5, s[8:11], s30 offen lds
v_mfma_f32_16x16x32_bf16 v[112:115], a[64:67], a[16:19], v[112:115]
ds_read_b64_tr_b16 a[76:77], v4 offset:8704
v_cvt_pk_bf16_f32 v26, v28, v29
v_mfma_f32_16x16x32_bf16 v[112:115], a[68:71], a[20:23], v[112:115]
v_cvt_pk_bf16_f32 v27, v30, v31
v_accvgpr_read_b32 v32, a216
v_mfma_f32_16x16x32_bf16 v[116:119], a[68:71], a[28:31], v[116:119]
buffer_store_dwordx4 v[24:27], v15, s[12:15], s101 offen offset:256 sc1
ds_read_b64_tr_b16 a[78:79], v4 offset:12800
v_accvgpr_read_b32 v33, a217
v_accvgpr_read_b32 v34, a218
v_mfma_f32_16x16x32_bf16 v[28:31], a[212:215], a[180:183], 0
ds_write_b128 v9, v[24:27] offset:14336
v_mfma_f32_16x16x32_bf16 v[24:27], a[208:211], a[180:183], 0
v_accvgpr_read_b32 v35, a219
v_mul_f32 v16, v16, v32
v_mul_f32 v17, v17, v33
v_mfma_f32_16x16x32_bf16 v[116:119], a[64:67], a[24:27], v[116:119]
s_sub_u32 s6, s77, s60
v_add_u32 v9, s6, v0
v_mul_f32 v18, v18, v34
v_mfma_f32_16x16x32_bf16 v[120:123], a[64:67], a[32:35], v[120:123]
buffer_load_dwordx4 v6, s[8:11], s30 offen offset:1024 lds
v_mfma_f32_16x16x32_bf16 v[120:123], a[68:71], a[36:39], v[120:123]
v_mul_f32 v19, v19, v35
v_accvgpr_read_b32 v32, a224
v_mfma_f32_16x16x32_bf16 v[124:127], a[68:71], a[44:47], v[124:127]
v_accvgpr_read_b32 v33, a225
v_accvgpr_read_b32 v34, a226
v_mfma_f32_16x16x32_bf16 v[124:127], a[64:67], a[40:43], v[124:127]
v_accvgpr_read_b32 v35, a227
v_mul_f32 v20, v20, v32
v_mfma_f32_16x16x32_bf16 v[128:131], a[64:67], a[48:51], v[128:131]
v_mul_f32 v21, v21, v33
v_mul_f32 v22, v22, v34
v_mfma_f32_16x16x32_bf16 v[128:131], a[68:71], a[52:55], v[128:131]
buffer_load_dwordx4 v5, s[8:11], s31 offen offset:2048 lds
v_mfma_f32_16x16x32_bf16 v[132:135], a[68:71], a[60:63], v[132:135]
v_mul_f32 v23, v23, v35
v_cvt_pk_bf16_f32 v16, v16, v17
v_cvt_pk_bf16_f32 v17, v18, v19
v_mfma_f32_16x16x32_bf16 v[132:135], a[64:67], a[56:59], v[132:135]
s_waitcnt lgkmcnt(1)
v_cvt_pk_bf16_f32 v18, v20, v21
v_cvt_pk_bf16_f32 v19, v22, v23
v_mfma_f32_16x16x32_bf16 v[136:139], a[72:75], a[0:3], v[136:139]
ds_read_b64_tr_b16 a[64:65], v3 offset:16384
v_accvgpr_read_b32 v32, a220
v_mfma_f32_16x16x32_bf16 v[20:23], a[212:215], a[184:187], 0
ds_write_b128 v9, v[16:19] offset:0
v_mfma_f32_16x16x32_bf16 v[16:19], a[208:211], a[184:187], 0
v_accvgpr_read_b32 v33, a221
v_accvgpr_read_b32 v34, a222
v_mfma_f32_16x16x32_bf16 v[136:139], a[76:79], a[4:7], v[136:139]
v_accvgpr_read_b32 v35, a223
v_mul_f32 v24, v24, v32
v_mfma_f32_16x16x32_bf16 v[140:143], a[76:79], a[12:15], v[140:143]
ds_read_b64_tr_b16 a[66:67], v3 offset:20480
v_mul_f32 v25, v25, v33
v_mfma_f32_16x16x32_bf16 v[140:143], a[72:75], a[8:11], v[140:143]
buffer_load_dwordx4 v6, s[8:11], s31 offen offset:3072 lds
v_mfma_f32_16x16x32_bf16 v[144:147], a[72:75], a[16:19], v[144:147]
ds_read_b64_tr_b16 a[68:69], v3 offset:24576
v_mul_f32 v26, v26, v34
v_mul_f32 v27, v27, v35
v_mfma_f32_16x16x32_bf16 v[144:147], a[76:79], a[20:23], v[144:147]
v_accvgpr_read_b32 v32, a228
v_accvgpr_read_b32 v33, a229
v_mfma_f32_16x16x32_bf16 v[148:151], a[76:79], a[28:31], v[148:151]
ds_read_b64_tr_b16 a[70:71], v3 offset:28672
v_accvgpr_read_b32 v34, a230
v_mfma_f32_16x16x32_bf16 v[148:151], a[72:75], a[24:27], v[148:151]
v_accvgpr_read_b32 v35, a231
v_mul_f32 v28, v28, v32
v_mfma_f32_16x16x32_bf16 v[152:155], a[72:75], a[32:35], v[152:155]
v_mul_f32 v29, v29, v33
v_mul_f32 v30, v30, v34
v_mfma_f32_16x16x32_bf16 v[152:155], a[76:79], a[36:39], v[152:155]
v_mul_f32 v31, v31, v35
v_cvt_pk_bf16_f32 v24, v24, v25
v_mfma_f32_16x16x32_bf16 v[156:159], a[76:79], a[44:47], v[156:159]
v_cvt_pk_bf16_f32 v25, v26, v27
v_cvt_pk_bf16_f32 v26, v28, v29
v_mfma_f32_16x16x32_bf16 v[156:159], a[72:75], a[40:43], v[156:159]
v_cvt_pk_bf16_f32 v27, v30, v31
v_mul_f32 v16, v16, v232
v_mfma_f32_16x16x32_bf16 v[28:31], a[212:215], a[188:191], 0
ds_write_b128 v9, v[24:27] offset:2048
v_mfma_f32_16x16x32_bf16 v[24:27], a[208:211], a[188:191], 0
v_mul_f32 v17, v17, v233
v_mul_f32 v18, v18, v234
v_mul_f32 v19, v19, v235
v_mfma_f32_16x16x32_bf16 v[160:163], a[72:75], a[48:51], v[160:163]
s_waitcnt vmcnt(15)
s_barrier
v_mfma_f32_16x16x32_bf16 v[160:163], a[76:79], a[52:55], v[160:163]
s_add_u32 s41, s41, 1
v_mov_b32 v11, s51
v_accvgpr_read_b32 v32, a232
v_mfma_f32_16x16x32_bf16 v[164:167], a[76:79], a[60:63], v[164:167]
buffer_store_dword v11, off, s[16:19], s48 sc1
v_mfma_f32_16x16x32_bf16 v[164:167], a[72:75], a[56:59], v[164:167]
s_waitcnt lgkmcnt(1)
v_accvgpr_read_b32 v33, a233
v_accvgpr_read_b32 v34, a234
v_mfma_f32_16x16x32_bf16 v[168:171], a[64:67], a[0:3], v[168:171]
s_add_u32 s51, s51, 1
ds_read_b64_tr_b16 a[72:73], v4 offset:16384
v_accvgpr_read_b32 v35, a235
v_mfma_f32_16x16x32_bf16 v[168:171], a[68:71], a[4:7], v[168:171]
s_add_u32 s42, s41, 1
v_mul_f32 v20, v20, v32
v_mul_f32 v21, v21, v33
v_mfma_f32_16x16x32_bf16 v[172:175], a[68:71], a[12:15], v[172:175]
s_mov_b32 s43, s96
ds_read_b64_tr_b16 a[74:75], v4 offset:20480
v_mul_f32 v22, v22, v34
v_mfma_f32_16x16x32_bf16 v[172:175], a[64:67], a[8:11], v[172:175]
v_mul_f32 v23, v23, v35
v_cvt_pk_bf16_f32 v16, v16, v17
v_mfma_f32_16x16x32_bf16 v[176:179], a[64:67], a[16:19], v[176:179]
ds_read_b64_tr_b16 a[76:77], v4 offset:24576
v_cvt_pk_bf16_f32 v17, v18, v19
v_cvt_pk_bf16_f32 v18, v20, v21
v_mfma_f32_16x16x32_bf16 v[176:179], a[68:71], a[20:23], v[176:179]
v_cvt_pk_bf16_f32 v19, v22, v23
v_mul_f32 v24, v24, v236
v_mfma_f32_16x16x32_bf16 v[180:183], a[68:71], a[28:31], v[180:183]
buffer_store_dwordx4 v[16:19], v15, s[12:15], s34 offen offset:384 sc1
ds_read_b64_tr_b16 a[78:79], v4 offset:28672
v_mul_f32 v25, v25, v237
v_mul_f32 v26, v26, v238
v_mfma_f32_16x16x32_bf16 v[20:23], a[212:215], a[192:195], 0
ds_write_b128 v9, v[16:19] offset:4096
v_mfma_f32_16x16x32_bf16 v[16:19], a[208:211], a[192:195], 0
v_mul_f32 v27, v27, v239
v_accvgpr_read_b32 v32, a236
v_mfma_f32_16x16x32_bf16 v[180:183], a[64:67], a[24:27], v[180:183]
v_accvgpr_read_b32 v33, a237
v_accvgpr_read_b32 v34, a238
v_mfma_f32_16x16x32_bf16 v[184:187], a[64:67], a[32:35], v[184:187]
v_accvgpr_read_b32 v35, a239
v_mul_f32 v28, v28, v32
v_mfma_f32_16x16x32_bf16 v[184:187], a[68:71], a[36:39], v[184:187]
v_mul_f32 v29, v29, v33
v_mul_f32 v30, v30, v34
v_mfma_f32_16x16x32_bf16 v[188:191], a[68:71], a[44:47], v[188:191]
v_mul_f32 v31, v31, v35
v_cvt_pk_bf16_f32 v24, v24, v25
v_mfma_f32_16x16x32_bf16 v[188:191], a[64:67], a[40:43], v[188:191]
v_cvt_pk_bf16_f32 v25, v26, v27
v_cvt_pk_bf16_f32 v26, v28, v29
v_cvt_pk_bf16_f32 v27, v30, v31
v_mfma_f32_16x16x32_bf16 v[28:31], a[212:215], a[196:199], 0
ds_write_b128 v9, v[24:27] offset:6144
v_mfma_f32_16x16x32_bf16 v[24:27], a[208:211], a[196:199], 0
v_mul_f32 v16, v16, v240
v_mul_f32 v17, v17, v241
v_mfma_f32_16x16x32_bf16 v[192:195], a[64:67], a[48:51], v[192:195]
v_mul_f32 v18, v18, v242
v_mul_f32 v19, v19, v243
v_mfma_f32_16x16x32_bf16 v[192:195], a[68:71], a[52:55], v[192:195]
v_accvgpr_read_b32 v32, a240
v_accvgpr_read_b32 v33, a241
v_mfma_f32_16x16x32_bf16 v[196:199], a[68:71], a[60:63], v[196:199]
v_accvgpr_read_b32 v34, a242
v_accvgpr_read_b32 v35, a243
v_mfma_f32_16x16x32_bf16 v[196:199], a[64:67], a[56:59], v[196:199]
s_waitcnt lgkmcnt(2)
v_mul_f32 v20, v20, v32
v_mul_f32 v21, v21, v33
v_mfma_f32_16x16x32_bf16 v[200:203], a[72:75], a[0:3], v[200:203]
ds_read_b64_tr_b16 a[64:65], v3 offset:16896
v_mul_f32 v22, v22, v34
v_mfma_f32_16x16x32_bf16 v[200:203], a[76:79], a[4:7], v[200:203]
v_mul_f32 v23, v23, v35
v_cvt_pk_bf16_f32 v16, v16, v17
v_mfma_f32_16x16x32_bf16 v[204:207], a[76:79], a[12:15], v[204:207]
ds_read_b64_tr_b16 a[66:67], v3 offset:20992
v_cvt_pk_bf16_f32 v17, v18, v19
v_cvt_pk_bf16_f32 v18, v20, v21
v_mfma_f32_16x16x32_bf16 v[204:207], a[72:75], a[8:11], v[204:207]
v_cvt_pk_bf16_f32 v19, v22, v23
v_mul_f32 v24, v24, v244
v_mfma_f32_16x16x32_bf16 v[208:211], a[72:75], a[16:19], v[208:211]
ds_read_b64_tr_b16 a[68:69], v3 offset:25088
v_mul_f32 v25, v25, v245
v_mfma_f32_16x16x32_bf16 v[20:23], a[212:215], a[200:203], 0
ds_write_b128 v9, v[16:19] offset:8192
v_mfma_f32_16x16x32_bf16 v[16:19], a[208:211], a[200:203], 0
v_mul_f32 v26, v26, v246
v_mul_f32 v27, v27, v247
v_mfma_f32_16x16x32_bf16 v[208:211], a[76:79], a[20:23], v[208:211]
v_accvgpr_read_b32 v32, a244
v_accvgpr_read_b32 v33, a245
v_mfma_f32_16x16x32_bf16 v[212:215], a[76:79], a[28:31], v[212:215]
ds_read_b64_tr_b16 a[70:71], v3 offset:29184
v_accvgpr_read_b32 v34, a246
v_mfma_f32_16x16x32_bf16 v[212:215], a[72:75], a[24:27], v[212:215]
v_accvgpr_read_b32 v35, a247
v_mul_f32 v28, v28, v32
v_mfma_f32_16x16x32_bf16 v[216:219], a[72:75], a[32:35], v[216:219]
v_mul_f32 v29, v29, v33
v_mul_f32 v30, v30, v34
v_mfma_f32_16x16x32_bf16 v[216:219], a[76:79], a[36:39], v[216:219]
v_mul_f32 v31, v31, v35
v_cvt_pk_bf16_f32 v24, v24, v25
v_cvt_pk_bf16_f32 v25, v26, v27
v_mfma_f32_16x16x32_bf16 v[220:223], a[76:79], a[44:47], v[220:223]
v_cvt_pk_bf16_f32 v26, v28, v29
v_cvt_pk_bf16_f32 v27, v30, v31
v_mfma_f32_16x16x32_bf16 v[220:223], a[72:75], a[40:43], v[220:223]
buffer_store_dwordx4 v[24:27], v15, s[12:15], s63 offen offset:384 sc1
v_mul_f32 v16, v16, v248
v_mul_f32 v17, v17, v249
v_mul_f32 v18, v18, v250
v_mfma_f32_16x16x32_bf16 v[28:31], a[212:215], a[204:207], 0
ds_write_b128 v9, v[24:27] offset:10240
v_mfma_f32_16x16x32_bf16 v[24:27], a[208:211], a[204:207], 0
v_mul_f32 v19, v19, v251
v_accvgpr_read_b32 v32, a248
v_mfma_f32_16x16x32_bf16 v[224:227], a[72:75], a[48:51], v[224:227]
s_mov_b32 s36, s37
v_accvgpr_read_b32 v33, a249
v_accvgpr_read_b32 v34, a250
v_mfma_f32_16x16x32_bf16 v[224:227], a[76:79], a[52:55], v[224:227]
s_mov_b32 s37, s76
v_accvgpr_read_b32 v35, a251
v_mul_f32 v20, v20, v32
v_mfma_f32_16x16x32_bf16 v[228:231], a[76:79], a[60:63], v[228:231]
s_mov_b32 s38, s77
v_mul_f32 v21, v21, v33
v_mul_f32 v22, v22, v34
v_mfma_f32_16x16x32_bf16 v[228:231], a[72:75], a[56:59], v[228:231]
s_waitcnt lgkmcnt(1)
v_mul_f32 v23, v23, v35
v_cvt_pk_bf16_f32 v16, v16, v17
v_mfma_f32_16x16x32_bf16 a[216:219], a[64:67], a[0:3], a[216:219]
s_mov_b32 s5, s39
ds_read_b64_tr_b16 a[72:73], v4 offset:16896
v_cvt_pk_bf16_f32 v17, v18, v19
v_cvt_pk_bf16_f32 v18, v20, v21
v_mfma_f32_16x16x32_bf16 a[216:219], a[68:71], a[4:7], a[216:219]
s_mov_b32 s39, s40
v_cvt_pk_bf16_f32 v19, v22, v23
v_mul_f32 v24, v24, v252
v_mfma_f32_16x16x32_bf16 a[220:223], a[68:71], a[12:15], a[220:223]
s_mov_b32 s40, s5
ds_read_b64_tr_b16 a[74:75], v4 offset:20992
v_mul_f32 v25, v25, v253
v_mfma_f32_16x16x32_bf16 a[220:223], a[64:67], a[8:11], a[220:223]
v_mul_f32 v26, v26, v254
v_mul_f32 v27, v27, v255
v_mfma_f32_16x16x32_bf16 v[232:235], a[64:67], a[16:19], v[232:235]
ds_read_b64_tr_b16 a[76:77], v4 offset:25088
v_accvgpr_read_b32 v32, a252
v_mfma_f32_16x16x32_bf16 v[232:235], a[68:71], a[20:23], v[232:235]
v_accvgpr_read_b32 v33, a253
v_accvgpr_read_b32 v34, a254
v_mfma_f32_16x16x32_bf16 v[236:239], a[68:71], a[28:31], v[236:239]
ds_read_b64_tr_b16 a[78:79], v4 offset:29184
v_accvgpr_read_b32 v35, a255
v_mfma_f32_16x16x32_bf16 v[236:239], a[64:67], a[24:27], v[236:239]
ds_write_b128 v9, v[16:19] offset:12288
v_mfma_f32_16x16x32_bf16 v[240:243], a[64:67], a[32:35], v[240:243]
v_add_u32 v3, s4, v3
v_add_u32 v4, s4, v4
v_mfma_f32_16x16x32_bf16 v[240:243], a[68:71], a[36:39], v[240:243]
v_mul_f32 v28, v28, v32
v_mul_f32 v29, v29, v33
v_mul_f32 v30, v30, v34
v_mfma_f32_16x16x32_bf16 v[244:247], a[68:71], a[44:47], v[244:247]
v_mul_f32 v31, v31, v35
v_cvt_pk_bf16_f32 v24, v24, v25
v_mfma_f32_16x16x32_bf16 v[244:247], a[64:67], a[40:43], v[244:247]
v_cvt_pk_bf16_f32 v25, v26, v27
v_cvt_pk_bf16_f32 v26, v28, v29
v_mfma_f32_16x16x32_bf16 v[248:251], a[64:67], a[48:51], v[248:251]
v_cvt_pk_bf16_f32 v27, v30, v31
v_mfma_f32_16x16x32_bf16 v[248:251], a[68:71], a[52:55], v[248:251]
buffer_store_dwordx4 v[24:27], v15, s[12:15], s101 offen offset:384 sc1
v_mfma_f32_16x16x32_bf16 v[252:255], a[68:71], a[60:63], v[252:255]
ds_write_b128 v9, v[24:27] offset:14336
v_mfma_f32_16x16x32_bf16 v[252:255], a[64:67], a[56:59], v[252:255]
s_waitcnt vmcnt(4) lgkmcnt(0)
s_barrier
v_mfma_f32_16x16x32_bf16 a[224:227], a[72:75], a[0:3], a[224:227]
s_lshl_b32 s70, s41, 17
s_add_u32 s70, s70, s45
ds_read_b64_tr_b16 a[64:65], v3 offset:0
v_mfma_f32_16x16x32_bf16 a[224:227], a[76:79], a[4:7], a[224:227]
s_sub_u32 s71, s70, s44
s_mov_b32 s44, s70
ds_read_b64_tr_b16 a[66:67], v3 offset:4096
v_mfma_f32_16x16x32_bf16 a[228:231], a[76:79], a[12:15], a[228:231]
ds_read_b64_tr_b16 a[68:69], v3 offset:8192
v_add_u32 v5, s71, v5
v_mfma_f32_16x16x32_bf16 a[228:231], a[72:75], a[8:11], a[228:231]
ds_read_b128 a[0:3], v1 offset:0
v_add_u32 v6, s71, v6
v_mfma_f32_16x16x32_bf16 a[232:235], a[72:75], a[16:19], a[232:235]
ds_read_b128 a[4:7], v2 offset:0
v_mov_b32_dpp v33, v38 row_newbcast:5 row_mask:0xf bank_mask:0xf
v_mfma_f32_16x16x32_bf16 a[232:235], a[76:79], a[20:23], a[232:235]
ds_read_b128 a[12:15], v2 offset:2048
v_mov_b32_dpp v35, v39 row_newbcast:5 row_mask:0xf bank_mask:0xf
v_mfma_f32_16x16x32_bf16 a[236:239], a[76:79], a[28:31], a[236:239]
ds_read_b128 a[8:11], v1 offset:2048
v_lshlrev_b32 v32, 16, v33
v_mfma_f32_16x16x32_bf16 a[236:239], a[72:75], a[24:27], a[236:239]
ds_read_b128 a[16:19], v1 offset:4096
v_and_b32 v33, s65, v33
v_mfma_f32_16x16x32_bf16 a[240:243], a[72:75], a[32:35], a[240:243]
s_sub_u32 s6, s36, s60
ds_read_b64_tr_b16 a[70:71], v3 offset:12288
v_add_u32 v9, s6, v0
v_mfma_f32_16x16x32_bf16 a[240:243], a[76:79], a[36:39], a[240:243]
ds_read_b128 a[20:23], v2 offset:4096
v_lshlrev_b32 v34, 16, v35
v_mfma_f32_16x16x32_bf16 a[244:247], a[76:79], a[44:47], a[244:247]
ds_read_b128 a[28:31], v2 offset:6144
v_and_b32 v35, s65, v35
v_mfma_f32_16x16x32_bf16 a[244:247], a[72:75], a[40:43], a[244:247]
ds_read_b128 a[24:27], v1 offset:6144
v_add_f32 v200, v200, v32
v_mfma_f32_16x16x32_bf16 a[248:251], a[72:75], a[48:51], a[248:251]
s_mov_b32 m0, s40
ds_read_b128 a[32:35], v1 offset:8192
v_add_f32 v201, v201, v33
v_mfma_f32_16x16x32_bf16 a[248:251], a[76:79], a[52:55], a[248:251]
ds_read_b128 a[36:39], v2 offset:8192
v_add_f32 v202, v202, v34
v_mfma_f32_16x16x32_bf16 a[252:255], a[76:79], a[60:63], a[252:255]
HOP4:
s_cbranch_execz HOP8
buffer_load_dwordx4 v5, s[8:11], 0 offen lds
v_mfma_f32_16x16x32_bf16 a[252:255], a[72:75], a[56:59], a[252:255]
s_waitcnt lgkmcnt(5)
ds_read_b128 a[44:47], v2 offset:10240
v_add_f32 v203, v203, v35
v_mfma_f32_16x16x32_bf16 v[40:43], a[64:67], a[0:3], v[40:43]
ds_read_b128 a[40:43], v1 offset:10240
v_add_f32 v204, v204, v32
v_mfma_f32_16x16x32_bf16 v[40:43], a[68:71], a[4:7], v[40:43]
ds_read_b128 a[48:51], v1 offset:12288
v_add_f32 v205, v205, v33
v_mfma_f32_16x16x32_bf16 v[44:47], a[68:71], a[12:15], v[44:47]
ds_read_b128 a[52:55], v2 offset:12288
v_add_f32 v206, v206, v34
v_mfma_f32_16x16x32_bf16 v[44:47], a[64:67], a[8:11], v[44:47]
s_waitcnt lgkmcnt(6)
ds_read_b128 a[60:63], v2 offset:14336
v_add_f32 v207, v207, v35
v_mfma_f32_16x16x32_bf16 v[48:51], a[64:67], a[16:19], v[48:51]
ds_read_b64_tr_b16 a[72:73], v4 offset:0
v_add_f32 v208, v208, v32
v_mfma_f32_16x16x32_bf16 v[48:51], a[68:71], a[20:23], v[48:51]
ds_read_b128 a[56:59], v1 offset:14336
v_add_f32 v209, v209, v33
v_mfma_f32_16x16x32_bf16 v[52:55], a[68:71], a[28:31], v[52:55]
s_sub_u32 s79, s37, s36
ds_read_b64_tr_b16 a[74:75], v4 offset:4096
v_add_u32 v1, s79, v1
v_mfma_f32_16x16x32_bf16 v[52:55], a[64:67], a[24:27], v[52:55]
s_waitcnt lgkmcnt(8)
ds_read_b64_tr_b16 a[76:77], v4 offset:8192
v_add_u32 v2, s79, v2
v_mfma_f32_16x16x32_bf16 v[56:59], a[64:67], a[32:35], v[56:59]
s_sub_u32 s4, s40, s39
ds_read_b64_tr_b16 a[78:79], v4 offset:12288
v_add_f32 v210, v210, v34
v_mfma_f32_16x16x32_bf16 v[56:59], a[68:71], a[36:39], v[56:59]
s_waitcnt lgkmcnt(8)
v_add_f32 v211, v211, v35
v_add_f32 v212, v212, v32
v_mfma_f32_16x16x32_bf16 v[60:63], a[68:71], a[44:47], v[60:63]
buffer_load_dwordx4 v6, s[8:11], 0 offen offset:1024 lds
v_mfma_f32_16x16x32_bf16 v[60:63], a[64:67], a[40:43], v[60:63]
s_waitcnt lgkmcnt(6)
v_add_f32 v213, v213, v33
v_add_f32 v214, v214, v34
v_mfma_f32_16x16x32_bf16 v[64:67], a[64:67], a[48:51], v[64:67]
buffer_load_dwordx4 v5, s[8:11], s29 offen offset:2048 lds
v_mfma_f32_16x16x32_bf16 v[64:67], a[68:71], a[52:55], v[64:67]
s_waitcnt lgkmcnt(3)
v_add_f32 v215, v215, v35
v_add_f32 v216, v216, v32
v_mfma_f32_16x16x32_bf16 v[68:71], a[68:71], a[60:63], v[68:71]
v_add_f32 v217, v217, v33
v_add_f32 v218, v218, v34
v_mfma_f32_16x16x32_bf16 v[68:71], a[64:67], a[56:59], v[68:71]
s_waitcnt lgkmcnt(0)
v_add_f32 v219, v219, v35
v_add_f32 v220, v220, v32
v_mfma_f32_16x16x32_bf16 v[72:75], a[72:75], a[0:3], v[72:75]
ds_read_b64_tr_b16 a[64:65], v3 offset:512
v_add_f32 v221, v221, v33
v_mfma_f32_16x16x32_bf16 v[72:75], a[76:79], a[4:7], v[72:75]
v_add_f32 v222, v222, v34
v_add_f32 v223, v223, v35
v_mfma_f32_16x16x32_bf16 v[76:79], a[76:79], a[12:15], v[76:79]
ds_read_b64_tr_b16 a[66:67], v3 offset:4608
v_add_f32 v224, v224, v32
v_mfma_f32_16x16x32_bf16 v[76:79], a[72:75], a[8:11], v[76:79]
buffer_load_dwordx4 v6, s[8:11], s29 offen offset:3072 lds
v_mfma_f32_16x16x32_bf16 v[80:83], a[72:75], a[16:19], v[80:83]
ds_read_b64_tr_b16 a[68:69], v3 offset:8704
v_add_f32 v225, v225, v33
v_mfma_f32_16x16x32_bf16 v[80:83], a[76:79], a[20:23], v[80:83]
v_add_f32 v226, v226, v34
v_add_f32 v227, v227, v35
v_mfma_f32_16x16x32_bf16 v[84:87], a[76:79], a[28:31], v[84:87]
ds_read_b64_tr_b16 a[70:71], v3 offset:12800
v_add_f32 v228, v228, v32
v_mfma_f32_16x16x32_bf16 v[84:87], a[72:75], a[24:27], v[84:87]
v_add_f32 v229, v229, v33
v_add_f32 v230, v230, v34
v_mfma_f32_16x16x32_bf16 v[88:91], a[72:75], a[32:35], v[88:91]
s_add_u32 m0, s40, 0x1000
v_add_f32 v231, v231, v35
v_mov_b32_dpp v33, v38 row_newbcast:6 row_mask:0xf bank_mask:0xf
v_mfma_f32_16x16x32_bf16 v[88:91], a[76:79], a[36:39], v[88:91]
s_mov_b32 s5, s36
v_mov_b32_dpp v35, v39 row_newbcast:6 row_mask:0xf bank_mask:0xf
v_lshlrev_b32 v32, 16, v33
v_mfma_f32_16x16x32_bf16 v[92:95], a[76:79], a[44:47], v[92:95]
buffer_load_dwordx4 v5, s[8:11], s30 offen lds
v_mfma_f32_16x16x32_bf16 v[92:95], a[72:75], a[40:43], v[92:95]
s_mov_b32 s36, s37
v_and_b32 v33, s65, v33
v_lshlrev_b32 v34, 16, v35
v_mfma_f32_16x16x32_bf16 v[96:99], a[72:75], a[48:51], v[96:99]
s_mov_b32 s37, s38
v_and_b32 v35, s65, v35
v_accvgpr_read_b32 v36, a216
v_mfma_f32_16x16x32_bf16 v[96:99], a[76:79], a[52:55], v[96:99]
s_mov_b32 s38, s5
v_accvgpr_read_b32 v37, a217
v_add_f32 v36, v36, v32
v_mfma_f32_16x16x32_bf16 v[100:103], a[76:79], a[60:63], v[100:103]
s_mov_b32 s5, s39
v_add_f32 v37, v37, v33
v_accvgpr_write_b32 a216, v36
v_mfma_f32_16x16x32_bf16 v[100:103], a[72:75], a[56:59], v[100:103]
s_waitcnt lgkmcnt(0)
v_accvgpr_write_b32 a217, v37
v_accvgpr_read_b32 v36, a218
v_mfma_f32_16x16x32_bf16 v[104:107], a[64:67], a[0:3], v[104:107]
s_mov_b32 s39, s40
ds_read_b64_tr_b16 a[72:73], v4 offset:512
v_accvgpr_read_b32 v37, a219
v_mfma_f32_16x16x32_bf16 v[104:107], a[68:71], a[4:7], v[104:107]
buffer_load_dwordx4 v6, s[8:11], s30 offen offset:1024 lds
v_mfma_f32_16x16x32_bf16 v[108:111], a[68:71], a[12:15], v[108:111]
s_mov_b32 s40, s5
ds_read_b64_tr_b16 a[74:75], v4 offset:4608
v_add_f32 v36, v36, v34
v_mfma_f32_16x16x32_bf16 v[108:111], a[64:67], a[8:11], v[108:111]
v_add_f32 v37, v37, v35
v_accvgpr_write_b32 a218, v36
v_mfma_f32_16x16x32_bf16 v[112:115], a[64:67], a[16:19], v[112:115]
ds_read_b64_tr_b16 a[76:77], v4 offset:8704
v_accvgpr_write_b32 a219, v37
v_mfma_f32_16x16x32_bf16 v[112:115], a[68:71], a[20:23], v[112:115]
v_accvgpr_read_b32 v36, a220
v_accvgpr_read_b32 v37, a221
v_mfma_f32_16x16x32_bf16 v[116:119], a[68:71], a[28:31], v[116:119]
s_nop 0
ds_read_b64_tr_b16 a[78:79], v4 offset:12800
ds_read_b128 v[16:19], v9 offset:0
v_mfma_f32_16x16x32_bf16 v[116:119], a[64:67], a[24:27], v[116:119]
v_add_f32 v36, v36, v32
v_add_f32 v37, v37, v33
v_mfma_f32_16x16x32_bf16 v[120:123], a[64:67], a[32:35], v[120:123]
buffer_load_dwordx4 v5, s[8:11], s31 offen offset:2048 lds
v_mfma_f32_16x16x32_bf16 v[120:123], a[68:71], a[36:39], v[120:123]
v_accvgpr_write_b32 a220, v36
v_accvgpr_write_b32 a221, v37
v_mfma_f32_16x16x32_bf16 v[124:127], a[68:71], a[44:47], v[124:127]
s_lshr_b32 s53, s43, 2
s_lshl_b32 s53, s53, 7
s_add_u32 s53, s53, s47
v_mfma_f32_16x16x32_bf16 v[124:127], a[64:67], a[40:43], v[124:127]
buffer_load_dword v10, off, s[16:19], s53 sc1
v_mfma_f32_16x16x32_bf16 v[128:131], a[64:67], a[48:51], v[128:131]
v_accvgpr_read_b32 v36, a222
v_accvgpr_read_b32 v37, a223
v_mfma_f32_16x16x32_bf16 v[128:131], a[68:71], a[52:55], v[128:131]
v_add_f32 v36, v36, v34
v_add_f32 v37, v37, v35
v_mfma_f32_16x16x32_bf16 v[132:135], a[68:71], a[60:63], v[132:135]
v_accvgpr_write_b32 a222, v36
v_accvgpr_write_b32 a223, v37
v_mfma_f32_16x16x32_bf16 v[132:135], a[64:67], a[56:59], v[132:135]
s_waitcnt lgkmcnt(0)
v_add_f32 v232, v232, v32
v_add_f32 v233, v233, v33
v_mfma_f32_16x16x32_bf16 v[136:139], a[72:75], a[0:3], v[136:139]
ds_read_b64_tr_b16 a[64:65], v3 offset:16384
v_add_f32 v234, v234, v34
v_mfma_f32_16x16x32_bf16 v[136:139], a[76:79], a[4:7], v[136:139]
buffer_load_dwordx4 v6, s[8:11], s31 offen offset:3072 lds
v_mfma_f32_16x16x32_bf16 v[140:143], a[76:79], a[12:15], v[140:143]
ds_read_b64_tr_b16 a[66:67], v3 offset:20480
v_add_f32 v235, v235, v35
v_mfma_f32_16x16x32_bf16 v[140:143], a[72:75], a[8:11], v[140:143]
v_add_f32 v236, v236, v32
v_add_f32 v237, v237, v33
v_mfma_f32_16x16x32_bf16 v[144:147], a[72:75], a[16:19], v[144:147]
ds_read_b64_tr_b16 a[68:69], v3 offset:24576
v_add_f32 v238, v238, v34
v_mfma_f32_16x16x32_bf16 v[144:147], a[76:79], a[20:23], v[144:147]
v_add_f32 v239, v239, v35
v_add_f32 v240, v240, v32
v_mfma_f32_16x16x32_bf16 v[148:151], a[76:79], a[28:31], v[148:151]
s_nop 0
ds_read_b64_tr_b16 a[70:71], v3 offset:28672
ds_read_b128 v[20:23], v9 offset:2048
v_mfma_f32_16x16x32_bf16 v[148:151], a[72:75], a[24:27], v[148:151]
buffer_store_dwordx4 v[16:19], v15, s[12:15], 0 offen offset:128 sc1
v_mfma_f32_16x16x32_bf16 v[152:155], a[72:75], a[32:35], v[152:155]
ds_read_b128 v[24:27], v9 offset:6144
v_add_f32 v241, v241, v33
v_mfma_f32_16x16x32_bf16 v[152:155], a[76:79], a[36:39], v[152:155]
v_add_f32 v242, v242, v34
v_add_f32 v243, v243, v35
v_mfma_f32_16x16x32_bf16 v[156:159], a[76:79], a[44:47], v[156:159]
v_add_f32 v244, v244, v32
v_add_f32 v245, v245, v33
v_mfma_f32_16x16x32_bf16 v[156:159], a[72:75], a[40:43], v[156:159]
v_add_f32 v246, v246, v34
v_add_f32 v247, v247, v35
v_mfma_f32_16x16x32_bf16 v[160:163], a[72:75], a[48:51], v[160:163]
s_mov_b32 s41, s42
v_add_f32 v248, v248, v32
v_add_f32 v249, v249, v33
v_mfma_f32_16x16x32_bf16 v[160:163], a[76:79], a[52:55], v[160:163]
s_mov_b32 s42, s43
v_add_f32 v250, v250, v34
v_add_f32 v251, v251, v35
v_mfma_f32_16x16x32_bf16 v[164:167], a[76:79], a[60:63], v[164:167]
s_mov_b32 s43, s97
v_add_f32 v252, v252, v32
v_add_f32 v253, v253, v33
v_mfma_f32_16x16x32_bf16 v[164:167], a[72:75], a[56:59], v[164:167]
s_waitcnt lgkmcnt(0)
v_add_f32 v254, v254, v34
v_add_f32 v255, v255, v35
v_mfma_f32_16x16x32_bf16 v[168:171], a[64:67], a[0:3], v[168:171]
ds_read_b64_tr_b16 a[72:73], v4 offset:16384
v_mov_b32_dpp v33, v38 row_newbcast:0 row_mask:0xf bank_mask:0xf
v_mfma_f32_16x16x32_bf16 v[168:171], a[68:71], a[4:7], v[168:171]
buffer_store_dwordx4 v[20:23], v15, s[12:15], s33 offen offset:2176 sc1
v_mfma_f32_16x16x32_bf16 v[172:175], a[68:71], a[12:15], v[172:175]
ds_read_b64_tr_b16 a[74:75], v4 offset:20480
v_mov_b32_dpp v35, v39 row_newbcast:0 row_mask:0xf bank_mask:0xf
v_mfma_f32_16x16x32_bf16 v[172:175], a[64:67], a[8:11], v[172:175]
v_lshlrev_b32 v32, 16, v33
v_and_b32 v33, s65, v33
v_mfma_f32_16x16x32_bf16 v[176:179], a[64:67], a[16:19], v[176:179]
ds_read_b64_tr_b16 a[76:77], v4 offset:24576
v_lshlrev_b32 v34, 16, v35
v_mfma_f32_16x16x32_bf16 v[176:179], a[68:71], a[20:23], v[176:179]
v_and_b32 v35, s65, v35
v_add_f32 v40, v40, v32
v_mfma_f32_16x16x32_bf16 v[180:183], a[68:71], a[28:31], v[180:183]
s_nop 0
ds_read_b64_tr_b16 a[78:79], v4 offset:28672
ds_read_b128 v[28:31], v9 offset:8192
v_mfma_f32_16x16x32_bf16 v[180:183], a[64:67], a[24:27], v[180:183]
v_add_f32 v41, v41, v33
v_add_f32 v42, v42, v34
v_mfma_f32_16x16x32_bf16 v[184:187], a[64:67], a[32:35], v[184:187]
v_add_f32 v43, v43, v35
v_add_f32 v44, v44, v32
v_mfma_f32_16x16x32_bf16 v[184:187], a[68:71], a[36:39], v[184:187]
v_add_f32 v45, v45, v33
v_add_f32 v46, v46, v34
v_mfma_f32_16x16x32_bf16 v[188:191], a[68:71], a[44:47], v[188:191]
v_add_f32 v47, v47, v35
v_add_f32 v48, v48, v32
v_mfma_f32_16x16x32_bf16 v[188:191], a[64:67], a[40:43], v[188:191]
v_add_f32 v49, v49, v33
v_add_f32 v50, v50, v34
v_mfma_f32_16x16x32_bf16 v[192:195], a[64:67], a[48:51], v[192:195]
v_add_f32 v51, v51, v35
v_add_f32 v52, v52, v32
v_mfma_f32_16x16x32_bf16 v[192:195], a[68:71], a[52:55], v[192:195]
buffer_store_dwordx4 v[24:27], v15, s[12:15], s35 offen offset:2176 sc1
v_mfma_f32_16x16x32_bf16 v[196:199], a[68:71], a[60:63], v[196:199]
v_add_f32 v53, v53, v33
v_add_f32 v54, v54, v34
v_mfma_f32_16x16x32_bf16 v[196:199], a[64:67], a[56:59], v[196:199]
s_waitcnt lgkmcnt(0)
v_add_f32 v55, v55, v35
v_add_f32 v56, v56, v32
v_mfma_f32_16x16x32_bf16 v[200:203], a[72:75], a[0:3], v[200:203]
ds_read_b64_tr_b16 a[64:65], v3 offset:16896
v_add_f32 v57, v57, v33
v_mfma_f32_16x16x32_bf16 v[200:203], a[76:79], a[4:7], v[200:203]
v_add_f32 v58, v58, v34
v_add_f32 v59, v59, v35
v_mfma_f32_16x16x32_bf16 v[204:207], a[76:79], a[12:15], v[204:207]
ds_read_b64_tr_b16 a[66:67], v3 offset:20992
v_add_f32 v60, v60, v32
v_mfma_f32_16x16x32_bf16 v[204:207], a[72:75], a[8:11], v[204:207]
v_add_f32 v61, v61, v33
v_add_f32 v62, v62, v34
v_mfma_f32_16x16x32_bf16 v[208:211], a[72:75], a[16:19], v[208:211]
ds_read_b64_tr_b16 a[68:69], v3 offset:25088
v_add_f32 v63, v63, v35
v_mfma_f32_16x16x32_bf16 v[208:211], a[76:79], a[20:23], v[208:211]
v_add_f32 v64, v64, v32
v_add_f32 v65, v65, v33
v_mfma_f32_16x16x32_bf16 v[212:215], a[76:79], a[28:31], v[212:215]
s_nop 0
ds_read_b64_tr_b16 a[70:71], v3 offset:29184
ds_read_b128 v[16:19], v9 offset:12288
v_mfma_f32_16x16x32_bf16 v[212:215], a[72:75], a[24:27], v[212:215]
buffer_store_dwordx4 v[28:31], v15, s[12:15], s62 offen offset:128 sc1
v_mfma_f32_16x16x32_bf16 v[216:219], a[72:75], a[32:35], v[216:219]
v_add_f32 v66, v66, v34
v_add_f32 v67, v67, v35
v_mfma_f32_16x16x32_bf16 v[216:219], a[76:79], a[36:39], v[216:219]
v_add_f32 v68, v68, v32
v_add_f32 v69, v69, v33
v_mfma_f32_16x16x32_bf16 v[220:223], a[76:79], a[44:47], v[220:223]
v_add_f32 v70, v70, v34
v_add_f32 v71, v71, v35
v_mfma_f32_16x16x32_bf16 v[220:223], a[72:75], a[40:43], v[220:223]
v_mfma_f32_16x16x32_bf16 v[224:227], a[72:75], a[48:51], v[224:227]
v_mfma_f32_16x16x32_bf16 v[224:227], a[76:79], a[52:55], v[224:227]
v_mfma_f32_16x16x32_bf16 v[228:231], a[76:79], a[60:63], v[228:231]
v_mfma_f32_16x16x32_bf16 v[228:231], a[72:75], a[56:59], v[228:231]
s_waitcnt lgkmcnt(0)
v_mfma_f32_16x16x32_bf16 a[216:219], a[64:67], a[0:3], a[216:219]
ds_read_b64_tr_b16 a[72:73], v4 offset:16896
v_mfma_f32_16x16x32_bf16 a[216:219], a[68:71], a[4:7], a[216:219]
buffer_store_dwordx4 v[16:19], v15, s[12:15], s64 offen offset:128 sc1
v_mfma_f32_16x16x32_bf16 a[220:223], a[68:71], a[12:15], a[220:223]
ds_read_b64_tr_b16 a[74:75], v4 offset:20992
v_mfma_f32_16x16x32_bf16 a[220:223], a[64:67], a[8:11], a[220:223]
v_mfma_f32_16x16x32_bf16 v[232:235], a[64:67], a[16:19], v[232:235]
ds_read_b64_tr_b16 a[76:77], v4 offset:25088
v_mfma_f32_16x16x32_bf16 v[232:235], a[68:71], a[20:23], v[232:235]
v_mfma_f32_16x16x32_bf16 v[236:239], a[68:71], a[28:31], v[236:239]
ds_read_b64_tr_b16 a[78:79], v4 offset:29184
v_mfma_f32_16x16x32_bf16 v[236:239], a[64:67], a[24:27], v[236:239]
v_mfma_f32_16x16x32_bf16 v[240:243], a[64:67], a[32:35], v[240:243]
v_add_u32 v3, s4, v3
v_add_u32 v4, s4, v4
v_mfma_f32_16x16x32_bf16 v[240:243], a[68:71], a[36:39], v[240:243]
v_mfma_f32_16x16x32_bf16 v[244:247], a[68:71], a[44:47], v[244:247]
v_mfma_f32_16x16x32_bf16 v[244:247], a[64:67], a[40:43], v[244:247]
v_mfma_f32_16x16x32_bf16 v[248:251], a[64:67], a[48:51], v[248:251]
v_mfma_f32_16x16x32_bf16 v[248:251], a[68:71], a[52:55], v[248:251]
v_mfma_f32_16x16x32_bf16 v[252:255], a[68:71], a[60:63], v[252:255]
v_mfma_f32_16x16x32_bf16 v[252:255], a[64:67], a[56:59], v[252:255]
s_waitcnt vmcnt(5) lgkmcnt(0)
s_barrier
v_mfma_f32_16x16x32_bf16 a[224:227], a[72:75], a[0:3], a[224:227]
s_lshl_b32 s70, s41, 17
s_add_u32 s70, s70, s45
ds_read_b64_tr_b16 a[64:65], v3 offset:0
v_mfma_f32_16x16x32_bf16 a[224:227], a[76:79], a[4:7], a[224:227]
s_sub_u32 s71, s70, s44
s_mov_b32 s44, s70
ds_read_b64_tr_b16 a[66:67], v3 offset:4096
v_mfma_f32_16x16x32_bf16 a[228:231], a[76:79], a[12:15], a[228:231]
ds_read_b64_tr_b16 a[68:69], v3 offset:8192
v_add_u32 v5, s71, v5
v_mfma_f32_16x16x32_bf16 a[228:231], a[72:75], a[8:11], a[228:231]
ds_read_b128 a[0:3], v1 offset:0
v_add_u32 v6, s71, v6
v_mfma_f32_16x16x32_bf16 a[232:235], a[72:75], a[16:19], a[232:235]
ds_read_b128 a[4:7], v2 offset:0
v_mov_b32_dpp v33, v38 row_newbcast:4 row_mask:0xf bank_mask:0xf
v_mfma_f32_16x16x32_bf16 a[232:235], a[76:79], a[20:23], a[232:235]
ds_read_b128 a[12:15], v2 offset:2048
v_mov_b32_dpp v35, v39 row_newbcast:4 row_mask:0xf bank_mask:0xf
v_mfma_f32_16x16x32_bf16 a[236:239], a[76:79], a[28:31], a[236:239]
ds_read_b128 a[8:11], v1 offset:2048
v_lshlrev_b32 v32, 16, v33
v_mfma_f32_16x16x32_bf16 a[236:239], a[72:75], a[24:27], a[236:239]
ds_read_b128 a[16:19], v1 offset:4096
v_and_b32 v33, s65, v33
v_mfma_f32_16x16x32_bf16 a[240:243], a[72:75], a[32:35], a[240:243]
s_lshl_b32 s74, s42, 7
s_sub_u32 s79, s74, s3
ds_read_b64_tr_b16 a[70:71], v3 offset:12288
v_mfma_f32_16x16x32_bf16 a[240:243], a[76:79], a[36:39], a[240:243]
s_mov_b32 s3, s74
ds_read_b128 a[20:23], v2 offset:4096
v_add_u32 v7, s79, v7
v_mfma_f32_16x16x32_bf16 a[244:247], a[76:79], a[44:47], a[244:247]
s_sub_u32 s6, s36, s60
ds_read_b128 a[28:31], v2 offset:6144
v_add_u32 v8, s79, v8
v_mfma_f32_16x16x32_bf16 a[244:247], a[72:75], a[40:43], a[244:247]
ds_read_b128 a[24:27], v1 offset:6144
v_add_u32 v9, s6, v0
v_mfma_f32_16x16x32_bf16 a[248:251], a[72:75], a[48:51], a[248:251]
s_mov_b32 m0, s40
ds_read_b128 a[32:35], v1 offset:8192
v_lshlrev_b32 v34, 16, v35
v_mfma_f32_16x16x32_bf16 a[248:251], a[76:79], a[52:55], a[248:251]
ds_read_b128 a[36:39], v2 offset:8192
v_and_b32 v35, s65, v35
v_mfma_f32_16x16x32_bf16 a[252:255], a[76:79], a[60:63], a[252:255]
buffer_load_dwordx4 v5, s[8:11], 0 offen lds
v_mfma_f32_16x16x32_bf16 a[252:255], a[72:75], a[56:59], a[252:255]
s_waitcnt lgkmcnt(5)
ds_read_b128 a[44:47], v2 offset:10240
v_add_f32 v168, v168, v32
v_mfma_f32_16x16x32_bf16 v[40:43], a[64:67], a[0:3], v[40:43]
ds_read_b128 a[40:43], v1 offset:10240
v_add_f32 v169, v169, v33
v_mfma_f32_16x16x32_bf16 v[40:43], a[68:71], a[4:7], v[40:43]
ds_read_b128 a[48:51], v1 offset:12288
v_add_f32 v170, v170, v34
v_mfma_f32_16x16x32_bf16 v[44:47], a[68:71], a[12:15], v[44:47]
ds_read_b128 a[52:55], v2 offset:12288
v_add_f32 v171, v171, v35
v_mfma_f32_16x16x32_bf16 v[44:47], a[64:67], a[8:11], v[44:47]
s_waitcnt lgkmcnt(6)
ds_read_b128 a[60:63], v2 offset:14336
v_add_f32 v172, v172, v32
v_mfma_f32_16x16x32_bf16 v[48:51], a[64:67], a[16:19], v[48:51]
ds_read_b64_tr_b16 a[72:73], v4 offset:0
v_add_f32 v173, v173, v33
v_mfma_f32_16x16x32_bf16 v[48:51], a[68:71], a[20:23], v[48:51]
ds_read_b128 a[56:59], v1 offset:14336
v_add_f32 v174, v174, v34
v_mfma_f32_16x16x32_bf16 v[52:55], a[68:71], a[28:31], v[52:55]
s_sub_u32 s79, s37, s36
ds_read_b64_tr_b16 a[74:75], v4 offset:4096
v_add_u32 v1, s79, v1
v_mfma_f32_16x16x32_bf16 v[52:55], a[64:67], a[24:27], v[52:55]
s_waitcnt lgkmcnt(8)
ds_read_b64_tr_b16 a[76:77], v4 offset:8192
v_add_u32 v2, s79, v2
v_mfma_f32_16x16x32_bf16 v[56:59], a[64:67], a[32:35], v[56:59]
s_and_b32 s73, s42, 3
s_add_u32 s73, s73, s50
ds_read_b64_tr_b16 a[78:79], v4 offset:12288
v_mfma_f32_16x16x32_bf16 v[56:59], a[68:71], a[36:39], v[56:59]
s_waitcnt lgkmcnt(8)
s_sub_u32 s4, s40, s39
v_readfirstlane_b32 s72, v10
v_mfma_f32_16x16x32_bf16 v[60:63], a[68:71], a[44:47], v[60:63]
buffer_load_dwordx4 v6, s[8:11], 0 offen offset:1024 lds
v_mfma_f32_16x16x32_bf16 v[60:63], a[64:67], a[40:43], v[60:63]
s_waitcnt lgkmcnt(6)
s_sub_u32 s72, s72, s73
v_add_f32 v175, v175, v35
v_mfma_f32_16x16x32_bf16 v[64:67], a[64:67], a[48:51], v[64:67]
buffer_load_dwordx4 v5, s[8:11], s29 offen offset:2048 lds
v_mfma_f32_16x16x32_bf16 v[64:67], a[68:71], a[52:55], v[64:67]
s_waitcnt lgkmcnt(3)
s_cmp_gt_u32 s72, 7
v_add_f32 v176, v176, v32
v_mfma_f32_16x16x32_bf16 v[68:71], a[68:71], a[60:63], v[68:71]
s_cbranch_scc1 SLOW_S2
BACK_S2:
v_mfma_f32_16x16x32_bf16 v[68:71], a[64:67], a[56:59], v[68:71]
s_waitcnt lgkmcnt(0)
v_add_f32 v177, v177, v33
v_add_f32 v178, v178, v34
v_mfma_f32_16x16x32_bf16 v[72:75], a[72:75], a[0:3], v[72:75]
ds_read_b64_tr_b16 a[64:65], v3 offset:512
v_add_f32 v179, v179, v35
v_mfma_f32_16x16x32_bf16 v[72:75], a[76:79], a[4:7], v[72:75]
v_add_f32 v180, v180, v32
v_add_f32 v181, v181, v33
v_mfma_f32_16x16x32_bf16 v[76:79], a[76:79], a[12:15], v[76:79]
ds_read_b64_tr_b16 a[66:67], v3 offset:4608
v_add_f32 v182, v182, v34
v_mfma_f32_16x16x32_bf16 v[76:79], a[72:75], a[8:11], v[76:79]
buffer_load_dwordx4 v6, s[8:11], s29 offen offset:3072 lds
v_mfma_f32_16x16x32_bf16 v[80:83], a[72:75], a[16:19], v[80:83]
ds_read_b64_tr_b16 a[68:69], v3 offset:8704
v_add_f32 v183, v183, v35
v_mfma_f32_16x16x32_bf16 v[80:83], a[76:79], a[20:23], v[80:83]
v_add_f32 v184, v184, v32
v_add_f32 v185, v185, v33
v_mfma_f32_16x16x32_bf16 v[84:87], a[76:79], a[28:31], v[84:87]
ds_read_b64_tr_b16 a[70:71], v3 offset:12800
v_add_f32 v186, v186, v34
v_mfma_f32_16x16x32_bf16 v[84:87], a[72:75], a[24:27], v[84:87]
v_add_f32 v187, v187, v35
v_add_f32 v188, v188, v32
v_mfma_f32_16x16x32_bf16 v[88:91], a[72:75], a[32:35], v[88:91]
s_add_u32 m0, s40, 0x1000
v_add_f32 v189, v189, v33
v_add_f32 v190, v190, v34
v_mfma_f32_16x16x32_bf16 v[88:91], a[76:79], a[36:39], v[88:91]
v_add_f32 v191, v191, v35
v_add_f32 v192, v192, v32
v_mfma_f32_16x16x32_bf16 v[92:95], a[76:79], a[44:47], v[92:95]
buffer_load_dwordx4 v5, s[8:11], s30 offen lds
v_mfma_f32_16x16x32_bf16 v[92:95], a[72:75], a[40:43], v[92:95]
v_add_f32 v193, v193, v33
v_add_f32 v194, v194, v34
v_mfma_f32_16x16x32_bf16 v[96:99], a[72:75], a[48:51], v[96:99]
v_add_f32 v195, v195, v35
v_add_f32 v196, v196, v32
v_mfma_f32_16x16x32_bf16 v[96:99], a[76:79], a[52:55], v[96:99]
v_add_f32 v197, v197, v33
v_add_f32 v198, v198, v34
v_mfma_f32_16x16x32_bf16 v[100:103], a[76:79], a[60:63], v[100:103]
v_add_f32 v199, v199, v35
v_mov_b32_dpp v33, v38 row_newbcast:1 row_mask:0xf bank_mask:0xf
v_mfma_f32_16x16x32_bf16 v[100:103], a[72:75], a[56:59], v[100:103]
s_waitcnt lgkmcnt(0)
v_mov_b32_dpp v35, v39 row_newbcast:1 row_mask:0xf bank_mask:0xf
v_lshlrev_b32 v32, 16, v33
v_mfma_f32_16x16x32_bf16 v[104:107], a[64:67], a[0:3], v[104:107]
s_nop 0
ds_read_b64_tr_b16 a[72:73], v4 offset:512
ds_read_b128 v[24:27], v9 offset:8192
v_mfma_f32_16x16x32_bf16 v[104:107], a[68:71], a[4:7], v[104:107]
buffer_load_dwordx4 v6, s[8:11], s30 offen offset:1024 lds
v_mfma_f32_16x16x32_bf16 v[108:111], a[68:71], a[12:15], v[108:111]
s_nop 0
ds_read_b64_tr_b16 a[74:75], v4 offset:4608
ds_read_b128 v[28:31], v9 offset:12288
v_mfma_f32_16x16x32_bf16 v[108:111], a[64:67], a[8:11], v[108:111]
v_and_b32 v33, s65, v33
v_lshlrev_b32 v34, 16, v35
v_mfma_f32_16x16x32_bf16 v[112:115], a[64:67], a[16:19], v[112:115]
ds_read_b64_tr_b16 a[76:77], v4 offset:8704
v_and_b32 v35, s65, v35
v_mfma_f32_16x16x32_bf16 v[112:115], a[68:71], a[20:23], v[112:115]
v_mfma_f32_16x16x32_bf16 v[116:119], a[68:71], a[28:31], v[116:119]
s_nop 0
ds_read_b64_tr_b16 a[78:79], v4 offset:12800
ds_read_b128 v[16:19], v9 offset:0
v_mfma_f32_16x16x32_bf16 v[116:119], a[64:67], a[24:27], v[116:119]
v_add_f32 v72, v72, v32
v_add_f32 v73, v73, v33
v_mfma_f32_16x16x32_bf16 v[120:123], a[64:67], a[32:35], v[120:123]
buffer_load_dwordx4 v5, s[8:11], s31 offen offset:2048 lds
v_mfma_f32_16x16x32_bf16 v[120:123], a[68:71], a[36:39], v[120:123]
v_add_f32 v74, v74, v34
v_add_f32 v75, v75, v35
v_mfma_f32_16x16x32_bf16 v[124:127], a[68:71], a[44:47], v[124:127]
s_lshr_b32 s53, s43, 2
s_lshl_b32 s53, s53, 7
s_add_u32 s53, s53, s47
v_mfma_f32_16x16x32_bf16 v[124:127], a[64:67], a[40:43], v[124:127]
buffer_load_dword v10, off, s[16:19], s53 sc1
v_mfma_f32_16x16x32_bf16 v[128:131], a[64:67], a[48:51], v[128:131]
v_add_f32 v76, v76, v32
v_add_f32 v77, v77, v33
v_mfma_f32_16x16x32_bf16 v[128:131], a[68:71], a[52:55], v[128:131]
v_add_f32 v78, v78, v34
v_add_f32 v79, v79, v35
v_mfma_f32_16x16x32_bf16 v[132:135], a[68:71], a[60:63], v[132:135]
v_add_f32 v80, v80, v32
v_add_f32 v81, v81, v33
v_mfma_f32_16x16x32_bf16 v[132:135], a[64:67], a[56:59], v[132:135]
s_waitcnt lgkmcnt(0)
v_add_f32 v82, v82, v34
v_add_f32 v83, v83, v35
v_mfma_f32_16x16x32_bf16 v[136:139], a[72:75], a[0:3], v[136:139]
ds_read_b64_tr_b16 a[64:65], v3 offset:16384
v_add_f32 v84, v84, v32
v_mfma_f32_16x16x32_bf16 v[136:139], a[76:79], a[4:7], v[136:139]
buffer_load_dwordx4 v6, s[8:11], s31 offen offset:3072 lds
v_mfma_f32_16x16x32_bf16 v[140:143], a[76:79], a[12:15], v[140:143]
ds_read_b64_tr_b16 a[66:67], v3 offset:20480
v_add_f32 v85, v85, v33
v_mfma_f32_16x16x32_bf16 v[140:143], a[72:75], a[8:11], v[140:143]
v_add_f32 v86, v86, v34
v_add_f32 v87, v87, v35
v_mfma_f32_16x16x32_bf16 v[144:147], a[72:75], a[16:19], v[144:147]
ds_read_b64_tr_b16 a[68:69], v3 offset:24576
v_add_f32 v88, v88, v32
v_mfma_f32_16x16x32_bf16 v[144:147], a[76:79], a[20:23], v[144:147]
v_add_f32 v89, v89, v33
v_add_f32 v90, v90, v34
v_mfma_f32_16x16x32_bf16 v[148:151], a[76:79], a[28:31], v[148:151]
s_mov_b32 m0, s38
ds_read_b64_tr_b16 a[70:71], v3 offset:28672
v_add_f32 v91, v91, v35
v_mfma_f32_16x16x32_bf16 v[148:151], a[72:75], a[24:27], v[148:151]
v_add_f32 v92, v92, v32
v_add_f32 v93, v93, v33
v_mfma_f32_16x16x32_bf16 v[152:155], a[72:75], a[32:35], v[152:155]
buffer_load_dwordx4 v7, s[12:15], 0 offen sc1 lds
v_mfma_f32_16x16x32_bf16 v[152:155], a[76:79], a[36:39], v[152:155]
v_add_f32 v94, v94, v34
v_add_f32 v95, v95, v35
v_mfma_f32_16x16x32_bf16 v[156:159], a[76:79], a[44:47], v[156:159]
v_add_f32 v96, v96, v32
v_add_f32 v97, v97, v33
v_mfma_f32_16x16x32_bf16 v[156:159], a[72:75], a[40:43], v[156:159]
v_add_f32 v98, v98, v34
v_add_f32 v99, v99, v35
v_mfma_f32_16x16x32_bf16 v[160:163], a[72:75], a[48:51], v[160:163]
s_mov_b32 s41, s42
v_add_f32 v100, v100, v32
v_add_f32 v101, v101, v33
v_mfma_f32_16x16x32_bf16 v[160:163], a[76:79], a[52:55], v[160:163]
buffer_store_dwordx4 v[16:19], v15, s[12:15], 0 offen offset:256 sc1
v_mfma_f32_16x16x32_bf16 v[164:167], a[76:79], a[60:63], v[164:167]
s_mov_b32 s42, s43
v_add_f32 v102, v102, v34
v_add_f32 v103, v103, v35
v_mfma_f32_16x16x32_bf16 v[164:167], a[72:75], a[56:59], v[164:167]
s_waitcnt lgkmcnt(0)
s_mov_b32 s43, s98
v_mfma_f32_16x16x32_bf16 v[168:171], a[64:67], a[0:3], v[168:171]
ds_read_b64_tr_b16 a[72:73], v4 offset:16384
v_mfma_f32_16x16x32_bf16 v[168:171], a[68:71], a[4:7], v[168:171]
buffer_load_dwordx4 v8, s[12:15], 0 offen offset:1024 sc1 lds
v_mfma_f32_16x16x32_bf16 v[172:175], a[68:71], a[12:15], v[172:175]
ds_read_b64_tr_b16 a[74:75], v4 offset:20480
v_mfma_f32_16x16x32_bf16 v[172:175], a[64:67], a[8:11], v[172:175]
v_mfma_f32_16x16x32_bf16 v[176:179], a[64:67], a[16:19], v[176:179]
ds_read_b64_tr_b16 a[76:77], v4 offset:24576
v_mfma_f32_16x16x32_bf16 v[176:179], a[68:71], a[20:23], v[176:179]
v_mfma_f32_16x16x32_bf16 v[180:183], a[68:71], a[28:31], v[180:183]
s_nop 0
ds_read_b64_tr_b16 a[78:79], v4 offset:28672
ds_read_b128 v[20:23], v9 offset:4096
v_mfma_f32_16x16x32_bf16 v[180:183], a[64:67], a[24:27], v[180:183]
buffer_load_dwordx4 v7, s[12:15], s33 offen offset:2048 sc1 lds
v_mfma_f32_16x16x32_bf16 v[184:187], a[64:67], a[32:35], v[184:187]
v_mfma_f32_16x16x32_bf16 v[184:187], a[68:71], a[36:39], v[184:187]
v_mfma_f32_16x16x32_bf16 v[188:191], a[68:71], a[44:47], v[188:191]
v_mfma_f32_16x16x32_bf16 v[188:191], a[64:67], a[40:43], v[188:191]
v_mfma_f32_16x16x32_bf16 v[192:195], a[64:67], a[48:51], v[192:195]
v_mfma_f32_16x16x32_bf16 v[192:195], a[68:71], a[52:55], v[192:195]
v_mfma_f32_16x16x32_bf16 v[196:199], a[68:71], a[60:63], v[196:199]
buffer_load_dwordx4 v8, s[12:15], s33 offen offset:3072 sc1 lds
v_mfma_f32_16x16x32_bf16 v[196:199], a[64:67], a[56:59], v[196:199]
s_waitcnt lgkmcnt(0)
v_mfma_f32_16x16x32_bf16 v[200:203], a[72:75], a[0:3], v[200:203]
ds_read_b64_tr_b16 a[64:65], v3 offset:16896
v_mfma_f32_16x16x32_bf16 v[200:203], a[76:79], a[4:7], v[200:203]
v_mfma_f32_16x16x32_bf16 v[204:207], a[76:79], a[12:15], v[204:207]
ds_read_b64_tr_b16 a[66:67], v3 offset:20992
v_mfma_f32_16x16x32_bf16 v[204:207], a[72:75], a[8:11], v[204:207]
v_mfma_f32_16x16x32_bf16 v[208:211], a[72:75], a[16:19], v[208:211]
s_add_u32 m0, s38, 0x1000
ds_read_b64_tr_b16 a[68:69], v3 offset:25088
v_mfma_f32_16x16x32_bf16 v[208:211], a[76:79], a[20:23], v[208:211]
s_mov_b32 s5, s36
s_mov_b32 s36, s37
s_mov_b32 s37, s38
v_mfma_f32_16x16x32_bf16 v[212:215], a[76:79], a[28:31], v[212:215]
s_mov_b32 s38, s5
s_mov_b32 s5, s39
ds_read_b64_tr_b16 a[70:71], v3 offset:29184
v_mfma_f32_16x16x32_bf16 v[212:215], a[72:75], a[24:27], v[212:215]
buffer_load_dwordx4 v7, s[12:15], s34 offen sc1 lds
v_mfma_f32_16x16x32_bf16 v[216:219], a[72:75], a[32:35], v[216:219]
s_mov_b32 s39, s40
s_mov_b32 s40, s5
v_mfma_f32_16x16x32_bf16 v[216:219], a[76:79], a[36:39], v[216:219]
v_mfma_f32_16x16x32_bf16 v[220:223], a[76:79], a[44:47], v[220:223]
buffer_store_dwordx4 v[20:23], v15, s[12:15], s34 offen offset:256 sc1
v_mfma_f32_16x16x32_bf16 v[220:223], a[72:75], a[40:43], v[220:223]
v_mfma_f32_16x16x32_bf16 v[224:227], a[72:75], a[48:51], v[224:227]
v_mfma_f32_16x16x32_bf16 v[224:227], a[76:79], a[52:55], v[224:227]
buffer_load_dwordx4 v8, s[12:15], s34 offen offset:1024 sc1 lds
v_mfma_f32_16x16x32_bf16 v[228:231], a[76:79], a[60:63], v[228:231]
v_mfma_f32_16x16x32_bf16 v[228:231], a[72:75], a[56:59], v[228:231]
s_waitcnt lgkmcnt(0)
v_mfma_f32_16x16x32_bf16 a[216:219], a[64:67], a[0:3], a[216:219]
ds_read_b64_tr_b16 a[72:73], v4 offset:16896
v_mfma_f32_16x16x32_bf16 a[216:219], a[68:71], a[4:7], a[216:219]
v_mfma_f32_16x16x32_bf16 a[220:223], a[68:71], a[12:15], a[220:223]
ds_read_b64_tr_b16 a[74:75], v4 offset:20992
v_mfma_f32_16x16x32_bf16 a[220:223], a[64:67], a[8:11], a[220:223]
v_mfma_f32_16x16x32_bf16 v[232:235], a[64:67], a[16:19], v[232:235]
ds_read_b64_tr_b16 a[76:77], v4 offset:25088
v_mfma_f32_16x16x32_bf16 v[232:235], a[68:71], a[20:23], v[232:235]
buffer_load_dwordx4 v7, s[12:15], s35 offen offset:2048 sc1 lds
v_mfma_f32_16x16x32_bf16 v[236:239], a[68:71], a[28:31], v[236:239]
ds_read_b64_tr_b16 a[78:79], v4 offset:29184
v_mfma_f32_16x16x32_bf16 v[236:239], a[64:67], a[24:27], v[236:239]
HOP5:
s_cbranch_execz HOP9
v_mfma_f32_16x16x32_bf16 v[240:243], a[64:67], a[32:35], v[240:243]
v_add_u32 v3, s4, v3
v_add_u32 v4, s4, v4
v_mfma_f32_16x16x32_bf16 v[240:243], a[68:71], a[36:39], v[240:243]
v_mfma_f32_16x16x32_bf16 v[244:247], a[68:71], a[44:47], v[244:247]
v_mfma_f32_16x16x32_bf16 v[244:247], a[64:67], a[40:43], v[244:247]
v_mfma_f32_16x16x32_bf16 v[248:251], a[64:67], a[48:51], v[248:251]
buffer_load_dwordx4 v8, s[12:15], s35 offen offset:3072 sc1 lds
v_mfma_f32_16x16x32_bf16 v[248:251], a[68:71], a[52:55], v[248:251]
v_mfma_f32_16x16x32_bf16 v[252:255], a[68:71], a[60:63], v[252:255]
v_mfma_f32_16x16x32_bf16 v[252:255], a[64:67], a[56:59], v[252:255]
s_waitcnt vmcnt(10) lgkmcnt(0)
s_barrier
v_mfma_f32_16x16x32_bf16 a[224:227], a[72:75], a[0:3], a[224:227]
s_lshl_b32 s70, s41, 17
s_add_u32 s70, s70, s45
ds_read_b64_tr_b16 a[64:65], v3 offset:0
v_mfma_f32_16x16x32_bf16 a[224:227], a[76:79], a[4:7], a[224:227]
s_sub_u32 s71, s70, s44
s_mov_b32 s44, s70
ds_read_b64_tr_b16 a[66:67], v3 offset:4096
v_mfma_f32_16x16x32_bf16 a[228:231], a[76:79], a[12:15], a[228:231]
ds_read_b64_tr_b16 a[68:69], v3 offset:8192
v_add_u32 v5, s71, v5
v_mfma_f32_16x16x32_bf16 a[228:231], a[72:75], a[8:11], a[228:231]
ds_read_b128 a[0:3], v1 offset:0
v_add_u32 v6, s71, v6
v_mfma_f32_16x16x32_bf16 a[232:235], a[72:75], a[16:19], a[232:235]
ds_read_b128 a[4:7], v2 offset:0
v_mov_b32_dpp v33, v38 row_newbcast:3 row_mask:0xf bank_mask:0xf
v_mfma_f32_16x16x32_bf16 a[232:235], a[76:79], a[20:23], a[232:235]
ds_read_b128 a[12:15], v2 offset:2048
v_mov_b32_dpp v35, v39 row_newbcast:3 row_mask:0xf bank_mask:0xf
v_mfma_f32_16x16x32_bf16 a[236:239], a[76:79], a[28:31], a[236:239]
ds_read_b128 a[8:11], v1 offset:2048
v_lshlrev_b32 v32, 16, v33
v_mfma_f32_16x16x32_bf16 a[236:239], a[72:75], a[24:27], a[236:239]
ds_read_b128 a[16:19], v1 offset:4096
v_and_b32 v33, s65, v33
v_mfma_f32_16x16x32_bf16 a[240:243], a[72:75], a[32:35], a[240:243]
s_lshl_b32 s74, s42, 7
s_sub_u32 s79, s74, s3
ds_read_b64_tr_b16 a[70:71], v3 offset:12288
v_mfma_f32_16x16x32_bf16 a[240:243], a[76:79], a[36:39], a[240:243]
s_mov_b32 s3, s74
ds_read_b128 a[20:23], v2 offset:4096
v_add_u32 v7, s79, v7
v_mfma_f32_16x16x32_bf16 a[244:247], a[76:79], a[44:47], a[244:247]
s_sub_u32 s6, s36, s60
ds_read_b128 a[28:31], v2 offset:6144
v_add_u32 v8, s79, v8
v_mfma_f32_16x16x32_bf16 a[244:247], a[72:75], a[40:43], a[244:247]
ds_read_b128 a[24:27], v1 offset:6144
v_add_u32 v9, s6, v0
v_mfma_f32_16x16x32_bf16 a[248:251], a[72:75], a[48:51], a[248:251]
s_mov_b32 m0, s40
ds_read_b128 a[32:35], v1 offset:8192
v_lshlrev_b32 v34, 16, v35
v_mfma_f32_16x16x32_bf16 a[248:251], a[76:79], a[52:55], a[248:251]
ds_read_b128 a[36:39], v2 offset:8192
v_and_b32 v35, s65, v35
v_mfma_f32_16x16x32_bf16 a[252:255], a[76:79], a[60:63], a[252:255]
buffer_load_dwordx4 v5, s[8:11], 0 offen lds
v_mfma_f32_16x16x32_bf16 a[252:255], a[72:75], a[56:59], a[252:255]
s_waitcnt lgkmcnt(5)
ds_read_b128 a[44:47], v2 offset:10240
v_add_f32 v136, v136, v32
v_mfma_f32_16x16x32_bf16 v[40:43], a[64:67], a[0:3], v[40:43]
ds_read_b128 a[40:43], v1 offset:10240
v_add_f32 v137, v137, v33
v_mfma_f32_16x16x32_bf16 v[40:43], a[68:71], a[4:7], v[40:43]
ds_read_b128 a[48:51], v1 offset:12288
v_add_f32 v138, v138, v34
v_mfma_f32_16x16x32_bf16 v[44:47], a[68:71], a[12:15], v[44:47]
ds_read_b128 a[52:55], v2 offset:12288
v_add_f32 v139, v139, v35
v_mfma_f32_16x16x32_bf16 v[44:47], a[64:67], a[8:11], v[44:47]
s_waitcnt lgkmcnt(6)
ds_read_b128 a[60:63], v2 offset:14336
v_mov_b32 v11, s51
v_mfma_f32_16x16x32_bf16 v[48:51], a[64:67], a[16:19], v[48:51]
ds_read_b64_tr_b16 a[72:73], v4 offset:0
v_add_f32 v140, v140, v32
v_mfma_f32_16x16x32_bf16 v[48:51], a[68:71], a[20:23], v[48:51]
ds_read_b128 a[56:59], v1 offset:14336
v_add_f32 v141, v141, v33
v_mfma_f32_16x16x32_bf16 v[52:55], a[68:71], a[28:31], v[52:55]
s_sub_u32 s79, s37, s36
ds_read_b64_tr_b16 a[74:75], v4 offset:4096
v_add_u32 v1, s79, v1
v_mfma_f32_16x16x32_bf16 v[52:55], a[64:67], a[24:27], v[52:55]
s_waitcnt lgkmcnt(8)
ds_read_b64_tr_b16 a[76:77], v4 offset:8192
v_add_u32 v2, s79, v2
v_mfma_f32_16x16x32_bf16 v[56:59], a[64:67], a[32:35], v[56:59]
s_and_b32 s73, s42, 3
s_add_u32 s73, s73, s50
ds_read_b64_tr_b16 a[78:79], v4 offset:12288
v_mfma_f32_16x16x32_bf16 v[56:59], a[68:71], a[36:39], v[56:59]
s_waitcnt lgkmcnt(8)
s_sub_u32 s4, s40, s39
v_readfirstlane_b32 s72, v10
v_mfma_f32_16x16x32_bf16 v[60:63], a[68:71], a[44:47], v[60:63]
buffer_load_dwordx4 v6, s[8:11], 0 offen offset:1024 lds
v_mfma_f32_16x16x32_bf16 v[60:63], a[64:67], a[40:43], v[60:63]
s_waitcnt lgkmcnt(6)
s_sub_u32 s72, s72, s73
v_add_f32 v142, v142, v34
v_mfma_f32_16x16x32_bf16 v[64:67], a[64:67], a[48:51], v[64:67]
buffer_load_dwordx4 v5, s[8:11], s29 offen offset:2048 lds
v_mfma_f32_16x16x32_bf16 v[64:67], a[68:71], a[52:55], v[64:67]
s_waitcnt lgkmcnt(3)
s_cmp_gt_u32 s72, 7
v_add_f32 v143, v143, v35
v_mfma_f32_16x16x32_bf16 v[68:71], a[68:71], a[60:63], v[68:71]
s_cbranch_scc1 SLOW_S3
BACK_S3:
v_mfma_f32_16x16x32_bf16 v[68:71], a[64:67], a[56:59], v[68:71]
s_waitcnt lgkmcnt(0)
v_add_f32 v144, v144, v32
v_add_f32 v145, v145, v33
v_mfma_f32_16x16x32_bf16 v[72:75], a[72:75], a[0:3], v[72:75]
ds_read_b64_tr_b16 a[64:65], v3 offset:512
v_add_f32 v146, v146, v34
v_mfma_f32_16x16x32_bf16 v[72:75], a[76:79], a[4:7], v[72:75]
buffer_store_dword v11, off, s[16:19], s48 sc1
v_mfma_f32_16x16x32_bf16 v[76:79], a[76:79], a[12:15], v[76:79]
s_add_u32 s51, s51, 1
ds_read_b64_tr_b16 a[66:67], v3 offset:4608
v_add_f32 v147, v147, v35
v_mfma_f32_16x16x32_bf16 v[76:79], a[72:75], a[8:11], v[76:79]
buffer_load_dwordx4 v6, s[8:11], s29 offen offset:3072 lds
v_mfma_f32_16x16x32_bf16 v[80:83], a[72:75], a[16:19], v[80:83]
ds_read_b64_tr_b16 a[68:69], v3 offset:8704
v_add_f32 v148, v148, v32
v_mfma_f32_16x16x32_bf16 v[80:83], a[76:79], a[20:23], v[80:83]
v_add_f32 v149, v149, v33
v_add_f32 v150, v150, v34
v_mfma_f32_16x16x32_bf16 v[84:87], a[76:79], a[28:31], v[84:87]
ds_read_b64_tr_b16 a[70:71], v3 offset:12800
v_add_f32 v151, v151, v35
v_mfma_f32_16x16x32_bf16 v[84:87], a[72:75], a[24:27], v[84:87]
v_add_f32 v152, v152, v32
v_add_f32 v153, v153, v33
v_mfma_f32_16x16x32_bf16 v[88:91], a[72:75], a[32:35], v[88:91]
s_add_u32 m0, s40, 0x1000
v_add_f32 v154, v154, v34
v_add_f32 v155, v155, v35
v_mfma_f32_16x16x32_bf16 v[88:91], a[76:79], a[36:39], v[88:91]
v_add_f32 v156, v156, v32
v_add_f32 v157, v157, v33
v_mfma_f32_16x16x32_bf16 v[92:95], a[76:79], a[44:47], v[92:95]
buffer_load_dwordx4 v5, s[8:11], s30 offen lds
v_mfma_f32_16x16x32_bf16 v[92:95], a[72:75], a[40:43], v[92:95]
v_add_f32 v158, v158, v34
v_add_f32 v159, v159, v35
v_mfma_f32_16x16x32_bf16 v[96:99], a[72:75], a[48:51], v[96:99]
v_add_f32 v160, v160, v32
v_add_f32 v161, v161, v33
v_mfma_f32_16x16x32_bf16 v[96:99], a[76:79], a[52:55], v[96:99]
v_add_f32 v162, v162, v34
v_add_f32 v163, v163, v35
v_mfma_f32_16x16x32_bf16 v[100:103], a[76:79], a[60:63], v[100:103]
v_add_f32 v164, v164, v32
v_add_f32 v165, v165, v33
v_mfma_f32_16x16x32_bf16 v[100:103], a[72:75], a[56:59], v[100:103]
s_waitcnt lgkmcnt(0)
v_add_f32 v166, v166, v34
v_add_f32 v167, v167, v35
v_mfma_f32_16x16x32_bf16 v[104:107], a[64:67], a[0:3], v[104:107]
s_nop 0
ds_read_b64_tr_b16 a[72:73], v4 offset:512
ds_read_b128 v[20:23], v9 offset:2048
v_mfma_f32_16x16x32_bf16 v[104:107], a[68:71], a[4:7], v[104:107]
buffer_load_dwordx4 v6, s[8:11], s30 offen offset:1024 lds
v_mfma_f32_16x16x32_bf16 v[108:111], a[68:71], a[12:15], v[108:111]
ds_read_b64_tr_b16 a[74:75], v4 offset:4608
v_mov_b32_dpp v33, v38 row_newbcast:2 row_mask:0xf bank_mask:0xf
v_mfma_f32_16x16x32_bf16 v[108:111], a[64:67], a[8:11], v[108:111]
v_mov_b32_dpp v35, v39 row_newbcast:2 row_mask:0xf bank_mask:0xf
v_lshlrev_b32 v32, 16, v33
v_mfma_f32_16x16x32_bf16 v[112:115], a[64:67], a[16:19], v[112:115]
ds_read_b64_tr_b16 a[76:77], v4 offset:8704
v_and_b32 v33, s65, v33
v_mfma_f32_16x16x32_bf16 v[112:115], a[68:71], a[20:23], v[112:115]
v_lshlrev_b32 v34, 16, v35
v_and_b32 v35, s65, v35
v_mfma_f32_16x16x32_bf16 v[116:119], a[68:71], a[28:31], v[116:119]
ds_read_b64_tr_b16 a[78:79], v4 offset:12800
v_mfma_f32_16x16x32_bf16 v[116:119], a[64:67], a[24:27], v[116:119]
v_mfma_f32_16x16x32_bf16 v[120:123], a[64:67], a[32:35], v[120:123]
buffer_load_dwordx4 v5, s[8:11], s31 offen offset:2048 lds
v_mfma_f32_16x16x32_bf16 v[120:123], a[68:71], a[36:39], v[120:123]
v_mfma_f32_16x16x32_bf16 v[124:127], a[68:71], a[44:47], v[124:127]
s_lshr_b32 s53, s43, 2
s_lshl_b32 s53, s53, 7
s_add_u32 s53, s53, s47
v_mfma_f32_16x16x32_bf16 v[124:127], a[64:67], a[40:43], v[124:127]
buffer_load_dword v10, off, s[16:19], s53 sc1
v_mfma_f32_16x16x32_bf16 v[128:131], a[64:67], a[48:51], v[128:131]
v_mfma_f32_16x16x32_bf16 v[128:131], a[68:71], a[52:55], v[128:131]
v_mfma_f32_16x16x32_bf16 v[132:135], a[68:71], a[60:63], v[132:135]
v_mfma_f32_16x16x32_bf16 v[132:135], a[64:67], a[56:59], v[132:135]
s_waitcnt lgkmcnt(0)
v_mfma_f32_16x16x32_bf16 v[136:139], a[72:75], a[0:3], v[136:139]
ds_read_b64_tr_b16 a[64:65], v3 offset:16384
v_mfma_f32_16x16x32_bf16 v[136:139], a[76:79], a[4:7], v[136:139]
buffer_load_dwordx4 v6, s[8:11], s31 offen offset:3072 lds
v_mfma_f32_16x16x32_bf16 v[140:143], a[76:79], a[12:15], v[140:143]
ds_read_b64_tr_b16 a[66:67], v3 offset:20480
v_mfma_f32_16x16x32_bf16 v[140:143], a[72:75], a[8:11], v[140:143]
v_mfma_f32_16x16x32_bf16 v[144:147], a[72:75], a[16:19], v[144:147]
ds_read_b64_tr_b16 a[68:69], v3 offset:24576
v_mfma_f32_16x16x32_bf16 v[144:147], a[76:79], a[20:23], v[144:147]
v_mfma_f32_16x16x32_bf16 v[148:151], a[76:79], a[28:31], v[148:151]
s_mov_b32 m0, s38
ds_read_b64_tr_b16 a[70:71], v3 offset:28672
v_add_f32 v104, v104, v32
v_mfma_f32_16x16x32_bf16 v[148:151], a[72:75], a[24:27], v[148:151]
v_add_f32 v105, v105, v33
v_add_f32 v106, v106, v34
v_mfma_f32_16x16x32_bf16 v[152:155], a[72:75], a[32:35], v[152:155]
buffer_load_dwordx4 v7, s[12:15], 0 offen sc1 lds
v_mfma_f32_16x16x32_bf16 v[152:155], a[76:79], a[36:39], v[152:155]
v_add_f32 v107, v107, v35
v_add_f32 v108, v108, v32
v_mfma_f32_16x16x32_bf16 v[156:159], a[76:79], a[44:47], v[156:159]
v_add_f32 v109, v109, v33
v_add_f32 v110, v110, v34
v_mfma_f32_16x16x32_bf16 v[156:159], a[72:75], a[40:43], v[156:159]
v_add_f32 v111, v111, v35
v_add_f32 v112, v112, v32
v_mfma_f32_16x16x32_bf16 v[160:163], a[72:75], a[48:51], v[160:163]
buffer_store_dwordx4 v[24:27], v15, s[12:15], s62 offen offset:256 sc1
v_mfma_f32_16x16x32_bf16 v[160:163], a[76:79], a[52:55], v[160:163]
s_add_u32 s74, s41, 1
v_add_f32 v113, v113, v33
v_add_f32 v114, v114, v34
v_mfma_f32_16x16x32_bf16 v[164:167], a[76:79], a[60:63], v[164:167]
s_mov_b32 s41, s42
v_add_f32 v115, v115, v35
v_add_f32 v116, v116, v32
v_mfma_f32_16x16x32_bf16 v[164:167], a[72:75], a[56:59], v[164:167]
s_waitcnt lgkmcnt(0)
v_add_f32 v117, v117, v33
v_add_f32 v118, v118, v34
v_mfma_f32_16x16x32_bf16 v[168:171], a[64:67], a[0:3], v[168:171]
s_mov_b32 s42, s43
ds_read_b64_tr_b16 a[72:73], v4 offset:16384
ds_read_b128 v[24:27], v9 offset:6144
v_mfma_f32_16x16x32_bf16 v[168:171], a[68:71], a[4:7], v[168:171]
buffer_load_dwordx4 v8, s[12:15], 0 offen offset:1024 sc1 lds
v_mfma_f32_16x16x32_bf16 v[172:175], a[68:71], a[12:15], v[172:175]
s_mov_b32 s43, s74
ds_read_b64_tr_b16 a[74:75], v4 offset:20480
v_add_f32 v119, v119, v35
v_mfma_f32_16x16x32_bf16 v[172:175], a[64:67], a[8:11], v[172:175]
s_mov_b32 s57, 5
v_add_f32 v120, v120, v32
v_add_f32 v121, v121, v33
v_mfma_f32_16x16x32_bf16 v[176:179], a[64:67], a[16:19], v[176:179]
ds_read_b64_tr_b16 a[76:77], v4 offset:24576
v_add_f32 v122, v122, v34
v_mfma_f32_16x16x32_bf16 v[176:179], a[68:71], a[20:23], v[176:179]
v_add_f32 v123, v123, v35
v_add_f32 v124, v124, v32
v_mfma_f32_16x16x32_bf16 v[180:183], a[68:71], a[28:31], v[180:183]
s_nop 0
ds_read_b64_tr_b16 a[78:79], v4 offset:28672
ds_read_b128 v[16:19], v9 offset:0
v_mfma_f32_16x16x32_bf16 v[180:183], a[64:67], a[24:27], v[180:183]
buffer_load_dwordx4 v7, s[12:15], s33 offen offset:2048 sc1 lds
v_mfma_f32_16x16x32_bf16 v[184:187], a[64:67], a[32:35], v[184:187]
v_add_f32 v125, v125, v33
v_add_f32 v126, v126, v34
v_mfma_f32_16x16x32_bf16 v[184:187], a[68:71], a[36:39], v[184:187]
v_add_f32 v127, v127, v35
v_add_f32 v128, v128, v32
v_mfma_f32_16x16x32_bf16 v[188:191], a[68:71], a[44:47], v[188:191]
v_add_f32 v129, v129, v33
v_add_f32 v130, v130, v34
v_mfma_f32_16x16x32_bf16 v[188:191], a[64:67], a[40:43], v[188:191]
buffer_store_dwordx4 v[28:31], v15, s[12:15], s64 offen offset:256 sc1
v_mfma_f32_16x16x32_bf16 v[192:195], a[64:67], a[48:51], v[192:195]
v_add_f32 v131, v131, v35
v_add_f32 v132, v132, v32
v_mfma_f32_16x16x32_bf16 v[192:195], a[68:71], a[52:55], v[192:195]
v_add_f32 v133, v133, v33
v_add_f32 v134, v134, v34
v_mfma_f32_16x16x32_bf16 v[196:199], a[68:71], a[60:63], v[196:199]
buffer_load_dwordx4 v8, s[12:15], s33 offen offset:3072 sc1 lds
v_mfma_f32_16x16x32_bf16 v[196:199], a[64:67], a[56:59], v[196:199]
s_waitcnt lgkmcnt(0)
v_add_f32 v135, v135, v35
v_mfma_f32_16x16x32_bf16 v[200:203], a[72:75], a[0:3], v[200:203]
s_nop 0
ds_read_b64_tr_b16 a[64:65], v3 offset:16896
ds_read_b128 v[28:31], v9 offset:8192
v_mfma_f32_16x16x32_bf16 v[200:203], a[76:79], a[4:7], v[200:203]
v_mfma_f32_16x16x32_bf16 v[204:207], a[76:79], a[12:15], v[204:207]
ds_read_b64_tr_b16 a[66:67], v3 offset:20992
v_mfma_f32_16x16x32_bf16 v[204:207], a[72:75], a[8:11], v[204:207]
v_mfma_f32_16x16x32_bf16 v[208:211], a[72:75], a[16:19], v[208:211]
s_add_u32 m0, s38, 0x1000
ds_read_b64_tr_b16 a[68:69], v3 offset:25088
v_mfma_f32_16x16x32_bf16 v[208:211], a[76:79], a[20:23], v[208:211]
s_mov_b32 s5, s36
s_mov_b32 s36, s37
s_mov_b32 s37, s38
v_mfma_f32_16x16x32_bf16 v[212:215], a[76:79], a[28:31], v[212:215]
s_mov_b32 s38, s5
s_mov_b32 s5, s39
ds_read_b64_tr_b16 a[70:71], v3 offset:29184
v_mfma_f32_16x16x32_bf16 v[212:215], a[72:75], a[24:27], v[212:215]
buffer_load_dwordx4 v7, s[12:15], s34 offen sc1 lds
v_mfma_f32_16x16x32_bf16 v[216:219], a[72:75], a[32:35], v[216:219]
s_mov_b32 s39, s40
s_mov_b32 s40, s5
v_mfma_f32_16x16x32_bf16 v[216:219], a[76:79], a[36:39], v[216:219]
v_mfma_f32_16x16x32_bf16 v[220:223], a[76:79], a[44:47], v[220:223]
v_mfma_f32_16x16x32_bf16 v[220:223], a[72:75], a[40:43], v[220:223]
v_mfma_f32_16x16x32_bf16 v[224:227], a[72:75], a[48:51], v[224:227]
v_mfma_f32_16x16x32_bf16 v[224:227], a[76:79], a[52:55], v[224:227]
buffer_load_dwordx4 v8, s[12:15], s34 offen offset:1024 sc1 lds
v_mfma_f32_16x16x32_bf16 v[228:231], a[76:79], a[60:63], v[228:231]
v_mfma_f32_16x16x32_bf16 v[228:231], a[72:75], a[56:59], v[228:231]
s_waitcnt lgkmcnt(0)
v_mfma_f32_16x16x32_bf16 a[216:219], a[64:67], a[0:3], a[216:219]
ds_read_b64_tr_b16 a[72:73], v4 offset:16896
v_mfma_f32_16x16x32_bf16 a[216:219], a[68:71], a[4:7], a[216:219]
buffer_store_dwordx4 v[16:19], v15, s[12:15], 0 offen offset:384 sc1
v_mfma_f32_16x16x32_bf16 a[220:223], a[68:71], a[12:15], a[220:223]
s_nop 0
ds_read_b64_tr_b16 a[74:75], v4 offset:20992
ds_read_b128 v[16:19], v9 offset:12288
v_mfma_f32_16x16x32_bf16 a[220:223], a[64:67], a[8:11], a[220:223]
v_mfma_f32_16x16x32_bf16 v[232:235], a[64:67], a[16:19], v[232:235]
ds_read_b64_tr_b16 a[76:77], v4 offset:25088
v_mfma_f32_16x16x32_bf16 v[232:235], a[68:71], a[20:23], v[232:235]
buffer_load_dwordx4 v7, s[12:15], s35 offen offset:2048 sc1 lds
v_mfma_f32_16x16x32_bf16 v[236:239], a[68:71], a[28:31], v[236:239]
ds_read_b64_tr_b16 a[78:79], v4 offset:29184
v_mfma_f32_16x16x32_bf16 v[236:239], a[64:67], a[24:27], v[236:239]
v_mfma_f32_16x16x32_bf16 v[240:243], a[64:67], a[32:35], v[240:243]
v_add_u32 v3, s4, v3
v_add_u32 v4, s4, v4
v_mfma_f32_16x16x32_bf16 v[240:243], a[68:71], a[36:39], v[240:243]
v_mfma_f32_16x16x32_bf16 v[244:247], a[68:71], a[44:47], v[244:247]
v_mfma_f32_16x16x32_bf16 v[244:247], a[64:67], a[40:43], v[244:247]
v_mfma_f32_16x16x32_bf16 v[248:251], a[64:67], a[48:51], v[248:251]
buffer_load_dwordx4 v8, s[12:15], s35 offen offset:3072 sc1 lds
v_mfma_f32_16x16x32_bf16 v[248:251], a[68:71], a[52:55], v[248:251]
v_mfma_f32_16x16x32_bf16 v[252:255], a[68:71], a[60:63], v[252:255]
v_mfma_f32_16x16x32_bf16 v[252:255], a[64:67], a[56:59], v[252:255]
s_waitcnt vmcnt(11) lgkmcnt(0)
s_barrier
v_mfma_f32_16x16x32_bf16 a[224:227], a[72:75], a[0:3], a[224:227]
s_lshl_b32 s70, s41, 17
s_add_u32 s70, s70, s45
ds_read_b64_tr_b16 a[64:65], v3 offset:0
v_mfma_f32_16x16x32_bf16 a[224:227], a[76:79], a[4:7], a[224:227]
s_sub_u32 s71, s70, s44
s_mov_b32 s44, s70
ds_read_b64_tr_b16 a[66:67], v3 offset:4096
v_mfma_f32_16x16x32_bf16 a[228:231], a[76:79], a[12:15], a[228:231]
ds_read_b64_tr_b16 a[68:69], v3 offset:8192
v_add_u32 v5, s71, v5
v_mfma_f32_16x16x32_bf16 a[228:231], a[72:75], a[8:11], a[228:231]
ds_read_b128 a[0:3], v1 offset:0
v_add_u32 v6, s71, v6
v_mfma_f32_16x16x32_bf16 a[232:235], a[72:75], a[16:19], a[232:235]
ds_read_b128 a[4:7], v2 offset:0
v_mfma_f32_16x16x32_bf16 a[232:235], a[76:79], a[20:23], a[232:235]
ds_read_b128 a[12:15], v2 offset:2048
v_mfma_f32_16x16x32_bf16 a[236:239], a[76:79], a[28:31], a[236:239]
ds_read_b128 a[8:11], v1 offset:2048
v_mfma_f32_16x16x32_bf16 a[236:239], a[72:75], a[24:27], a[236:239]
ds_read_b128 a[16:19], v1 offset:4096
v_mfma_f32_16x16x32_bf16 a[240:243], a[72:75], a[32:35], a[240:243]
s_lshl_b32 s74, s42, 7
s_sub_u32 s79, s74, s3
ds_read_b64_tr_b16 a[70:71], v3 offset:12288
v_mfma_f32_16x16x32_bf16 a[240:243], a[76:79], a[36:39], a[240:243]
s_mov_b32 s3, s74
ds_read_b128 a[20:23], v2 offset:4096
v_add_u32 v7, s79, v7
v_mfma_f32_16x16x32_bf16 a[244:247], a[76:79], a[44:47], a[244:247]
ds_read_b128 a[28:31], v2 offset:6144
v_add_u32 v8, s79, v8
v_mfma_f32_16x16x32_bf16 a[244:247], a[72:75], a[40:43], a[244:247]
ds_read_b128 a[24:27], v1 offset:6144
v_mfma_f32_16x16x32_bf16 a[248:251], a[72:75], a[48:51], a[248:251]
s_mov_b32 m0, s40
ds_read_b128 a[32:35], v1 offset:8192
v_mfma_f32_16x16x32_bf16 a[248:251], a[76:79], a[52:55], a[248:251]
ds_read_b128 a[36:39], v2 offset:8192
v_mfma_f32_16x16x32_bf16 a[252:255], a[76:79], a[60:63], a[252:255]
buffer_load_dwordx4 v5, s[8:11], 0 offen lds
v_mfma_f32_16x16x32_bf16 a[252:255], a[72:75], a[56:59], a[252:255]
s_waitcnt lgkmcnt(5)
ds_read_b128 a[44:47], v2 offset:10240
v_mfma_f32_16x16x32_bf16 v[40:43], a[64:67], a[0:3], v[40:43]
ds_read_b128 a[40:43], v1 offset:10240
v_mfma_f32_16x16x32_bf16 v[40:43], a[68:71], a[4:7], v[40:43]
ds_read_b128 a[48:51], v1 offset:12288
v_mfma_f32_16x16x32_bf16 v[44:47], a[68:71], a[12:15], v[44:47]
ds_read_b128 a[52:55], v2 offset:12288
v_mfma_f32_16x16x32_bf16 v[44:47], a[64:67], a[8:11], v[44:47]
s_waitcnt lgkmcnt(6)
ds_read_b128 a[60:63], v2 offset:14336
v_mfma_f32_16x16x32_bf16 v[48:51], a[64:67], a[16:19], v[48:51]
ds_read_b64_tr_b16 a[72:73], v4 offset:0
v_mfma_f32_16x16x32_bf16 v[48:51], a[68:71], a[20:23], v[48:51]
ds_read_b128 a[56:59], v1 offset:14336
v_mfma_f32_16x16x32_bf16 v[52:55], a[68:71], a[28:31], v[52:55]
s_sub_u32 s79, s37, s36
ds_read_b64_tr_b16 a[74:75], v4 offset:4096
v_add_u32 v1, s79, v1
v_mfma_f32_16x16x32_bf16 v[52:55], a[64:67], a[24:27], v[52:55]
s_waitcnt lgkmcnt(8)
ds_read_b64_tr_b16 a[76:77], v4 offset:8192
v_add_u32 v2, s79, v2
v_mfma_f32_16x16x32_bf16 v[56:59], a[64:67], a[32:35], v[56:59]
s_and_b32 s73, s42, 3
s_add_u32 s73, s73, s50
ds_read_b64_tr_b16 a[78:79], v4 offset:12288
v_mfma_f32_16x16x32_bf16 v[56:59], a[68:71], a[36:39], v[56:59]
s_waitcnt lgkmcnt(8)
s_sub_u32 s4, s40, s39
v_readfirstlane_b32 s72, v10
v_mfma_f32_16x16x32_bf16 v[60:63], a[68:71], a[44:47], v[60:63]
buffer_load_dwordx4 v6, s[8:11], 0 offen offset:1024 lds
v_mfma_f32_16x16x32_bf16 v[60:63], a[64:67], a[40:43], v[60:63]
s_waitcnt lgkmcnt(6)
s_sub_u32 s72, s72, s73
v_mfma_f32_16x16x32_bf16 v[64:67], a[64:67], a[48:51], v[64:67]
buffer_load_dwordx4 v5, s[8:11], s29 offen offset:2048 lds
v_mfma_f32_16x16x32_bf16 v[64:67], a[68:71], a[52:55], v[64:67]
s_waitcnt lgkmcnt(3)
s_cmp_gt_u32 s72, 7
v_mfma_f32_16x16x32_bf16 v[68:71], a[68:71], a[60:63], v[68:71]
s_cbranch_scc1 SLOW_S4
BACK_S4:
v_mfma_f32_16x16x32_bf16 v[68:71], a[64:67], a[56:59], v[68:71]
s_waitcnt lgkmcnt(0)
v_mfma_f32_16x16x32_bf16 v[72:75], a[72:75], a[0:3], v[72:75]
ds_read_b64_tr_b16 a[64:65], v3 offset:512
v_mfma_f32_16x16x32_bf16 v[72:75], a[76:79], a[4:7], v[72:75]
v_mfma_f32_16x16x32_bf16 v[76:79], a[76:79], a[12:15], v[76:79]
ds_read_b64_tr_b16 a[66:67], v3 offset:4608
v_mfma_f32_16x16x32_bf16 v[76:79], a[72:75], a[8:11], v[76:79]
buffer_load_dwordx4 v6, s[8:11], s29 offen offset:3072 lds
v_mfma_f32_16x16x32_bf16 v[80:83], a[72:75], a[16:19], v[80:83]
ds_read_b64_tr_b16 a[68:69], v3 offset:8704
v_mfma_f32_16x16x32_bf16 v[80:83], a[76:79], a[20:23], v[80:83]
v_mfma_f32_16x16x32_bf16 v[84:87], a[76:79], a[28:31], v[84:87]
ds_read_b64_tr_b16 a[70:71], v3 offset:12800
v_mfma_f32_16x16x32_bf16 v[84:87], a[72:75], a[24:27], v[84:87]
v_mfma_f32_16x16x32_bf16 v[88:91], a[72:75], a[32:35], v[88:91]
s_add_u32 m0, s40, 0x1000
v_mfma_f32_16x16x32_bf16 v[88:91], a[76:79], a[36:39], v[88:91]
v_mfma_f32_16x16x32_bf16 v[92:95], a[76:79], a[44:47], v[92:95]
buffer_load_dwordx4 v5, s[8:11], s30 offen lds
v_mfma_f32_16x16x32_bf16 v[92:95], a[72:75], a[40:43], v[92:95]
v_mfma_f32_16x16x32_bf16 v[96:99], a[72:75], a[48:51], v[96:99]
v_mfma_f32_16x16x32_bf16 v[96:99], a[76:79], a[52:55], v[96:99]
v_mfma_f32_16x16x32_bf16 v[100:103], a[76:79], a[60:63], v[100:103]
v_mfma_f32_16x16x32_bf16 v[100:103], a[72:75], a[56:59], v[100:103]
s_waitcnt lgkmcnt(0)
v_mfma_f32_16x16x32_bf16 v[104:107], a[64:67], a[0:3], v[104:107]
ds_read_b64_tr_b16 a[72:73], v4 offset:512
v_mfma_f32_16x16x32_bf16 v[104:107], a[68:71], a[4:7], v[104:107]
buffer_load_dwordx4 v6, s[8:11], s30 offen offset:1024 lds
v_mfma_f32_16x16x32_bf16 v[108:111], a[68:71], a[12:15], v[108:111]
ds_read_b64_tr_b16 a[74:75], v4 offset:4608
v_mfma_f32_16x16x32_bf16 v[108:111], a[64:67], a[8:11], v[108:111]
v_mfma_f32_16x16x32_bf16 v[112:115], a[64:67], a[16:19], v[112:115]
ds_read_b64_tr_b16 a[76:77], v4 offset:8704
v_mfma_f32_16x16x32_bf16 v[112:115], a[68:71], a[20:23], v[112:115]
v_mfma_f32_16x16x32_bf16 v[116:119], a[68:71], a[28:31], v[116:119]
ds_read_b64_tr_b16 a[78:79], v4 offset:12800
v_mfma_f32_16x16x32_bf16 v[116:119], a[64:67], a[24:27], v[116:119]
v_mfma_f32_16x16x32_bf16 v[120:123], a[64:67], a[32:35], v[120:123]
buffer_load_dwordx4 v5, s[8:11], s31 offen offset:2048 lds
v_mfma_f32_16x16x32_bf16 v[120:123], a[68:71], a[36:39], v[120:123]
v_mfma_f32_16x16x32_bf16 v[124:127], a[68:71], a[44:47], v[124:127]
s_lshr_b32 s53, s43, 2
s_lshl_b32 s53, s53, 7
s_add_u32 s53, s53, s47
v_mfma_f32_16x16x32_bf16 v[124:127], a[64:67], a[40:43], v[124:127]
buffer_load_dword v10, off, s[16:19], s53 sc1
v_mfma_f32_16x16x32_bf16 v[128:131], a[64:67], a[48:51], v[128:131]
v_mfma_f32_16x16x32_bf16 v[128:131], a[68:71], a[52:55], v[128:131]
v_mfma_f32_16x16x32_bf16 v[132:135], a[68:71], a[60:63], v[132:135]
v_mfma_f32_16x16x32_bf16 v[132:135], a[64:67], a[56:59], v[132:135]
s_waitcnt lgkmcnt(0)
v_mfma_f32_16x16x32_bf16 v[136:139], a[72:75], a[0:3], v[136:139]
ds_read_b64_tr_b16 a[64:65], v3 offset:16384
v_mfma_f32_16x16x32_bf16 v[136:139], a[76:79], a[4:7], v[136:139]
buffer_load_dwordx4 v6, s[8:11], s31 offen offset:3072 lds
v_mfma_f32_16x16x32_bf16 v[140:143], a[76:79], a[12:15], v[140:143]
ds_read_b64_tr_b16 a[66:67], v3 offset:20480
v_mfma_f32_16x16x32_bf16 v[140:143], a[72:75], a[8:11], v[140:143]
v_mfma_f32_16x16x32_bf16 v[144:147], a[72:75], a[16:19], v[144:147]
ds_read_b64_tr_b16 a[68:69], v3 offset:24576
v_mfma_f32_16x16x32_bf16 v[144:147], a[76:79], a[20:23], v[144:147]
v_mfma_f32_16x16x32_bf16 v[148:151], a[76:79], a[28:31], v[148:151]
s_mov_b32 m0, s38
ds_read_b64_tr_b16 a[70:71], v3 offset:28672
v_mfma_f32_16x16x32_bf16 v[148:151], a[72:75], a[24:27], v[148:151]
v_mfma_f32_16x16x32_bf16 v[152:155], a[72:75], a[32:35], v[152:155]
buffer_load_dwordx4 v7, s[12:15], 0 offen sc1 lds
v_mfma_f32_16x16x32_bf16 v[152:155], a[76:79], a[36:39], v[152:155]
v_mfma_f32_16x16x32_bf16 v[156:159], a[76:79], a[44:47], v[156:159]
v_mfma_f32_16x16x32_bf16 v[156:159], a[72:75], a[40:43], v[156:159]
v_mfma_f32_16x16x32_bf16 v[160:163], a[72:75], a[48:51], v[160:163]
buffer_store_dwordx4 v[20:23], v15, s[12:15], s33 offen offset:2432 sc1
v_mfma_f32_16x16x32_bf16 v[160:163], a[76:79], a[52:55], v[160:163]
s_add_u32 s74, s41, 1
s_mov_b32 s41, s42
s_mov_b32 s42, s43
v_mfma_f32_16x16x32_bf16 v[164:167], a[76:79], a[60:63], v[164:167]
s_mov_b32 s43, s74
v_mfma_f32_16x16x32_bf16 v[164:167], a[72:75], a[56:59], v[164:167]
s_waitcnt lgkmcnt(0)
v_mfma_f32_16x16x32_bf16 v[168:171], a[64:67], a[0:3], v[168:171]
ds_read_b64_tr_b16 a[72:73], v4 offset:16384
v_mfma_f32_16x16x32_bf16 v[168:171], a[68:71], a[4:7], v[168:171]
buffer_load_dwordx4 v8, s[12:15], 0 offen offset:1024 sc1 lds
v_mfma_f32_16x16x32_bf16 v[172:175], a[68:71], a[12:15], v[172:175]
ds_read_b64_tr_b16 a[74:75], v4 offset:20480
v_mfma_f32_16x16x32_bf16 v[172:175], a[64:67], a[8:11], v[172:175]
v_mfma_f32_16x16x32_bf16 v[176:179], a[64:67], a[16:19], v[176:179]
ds_read_b64_tr_b16 a[76:77], v4 offset:24576
v_mfma_f32_16x16x32_bf16 v[176:179], a[68:71], a[20:23], v[176:179]
v_mfma_f32_16x16x32_bf16 v[180:183], a[68:71], a[28:31], v[180:183]
ds_read_b64_tr_b16 a[78:79], v4 offset:28672
v_mfma_f32_16x16x32_bf16 v[180:183], a[64:67], a[24:27], v[180:183]
buffer_load_dwordx4 v7, s[12:15], s33 offen offset:2048 sc1 lds
v_mfma_f32_16x16x32_bf16 v[184:187], a[64:67], a[32:35], v[184:187]
v_mfma_f32_16x16x32_bf16 v[184:187], a[68:71], a[36:39], v[184:187]
v_mfma_f32_16x16x32_bf16 v[188:191], a[68:71], a[44:47], v[188:191]
buffer_store_dwordx4 v[24:27], v15, s[12:15], s35 offen offset:2432 sc1
v_mfma_f32_16x16x32_bf16 v[188:191], a[64:67], a[40:43], v[188:191]
v_mfma_f32_16x16x32_bf16 v[192:195], a[64:67], a[48:51], v[192:195]
v_mfma_f32_16x16x32_bf16 v[192:195], a[68:71], a[52:55], v[192:195]
v_mfma_f32_16x16x32_bf16 v[196:199], a[68:71], a[60:63], v[196:199]
buffer_load_dwordx4 v8, s[12:15], s33 offen offset:3072 sc1 lds
v_mfma_f32_16x16x32_bf16 v[196:199], a[64:67], a[56:59], v[196:199]
s_waitcnt lgkmcnt(0)
v_mfma_f32_16x16x32_bf16 v[200:203], a[72:75], a[0:3], v[200:203]
ds_read_b64_tr_b16 a[64:65], v3 offset:16896
v_mfma_f32_16x16x32_bf16 v[200:203], a[76:79], a[4:7], v[200:203]
v_mfma_f32_16x16x32_bf16 v[204:207], a[76:79], a[12:15], v[204:207]
ds_read_b64_tr_b16 a[66:67], v3 offset:20992
v_mfma_f32_16x16x32_bf16 v[204:207], a[72:75], a[8:11], v[204:207]
buffer_store_dwordx4 v[28:31], v15, s[12:15], s62 offen offset:384 sc1
v_mfma_f32_16x16x32_bf16 v[208:211], a[72:75], a[16:19], v[208:211]
s_add_u32 m0, s38, 0x1000
ds_read_b64_tr_b16 a[68:69], v3 offset:25088
v_mfma_f32_16x16x32_bf16 v[208:211], a[76:79], a[20:23], v[208:211]
s_mov_b32 s5, s36
s_mov_b32 s36, s37
s_mov_b32 s37, s38
v_mfma_f32_16x16x32_bf16 v[212:215], a[76:79], a[28:31], v[212:215]
s_mov_b32 s38, s5
s_mov_b32 s5, s39
ds_read_b64_tr_b16 a[70:71], v3 offset:29184
v_mfma_f32_16x16x32_bf16 v[212:215], a[72:75], a[24:27], v[212:215]
buffer_load_dwordx4 v7, s[12:15], s34 offen sc1 lds
v_mfma_f32_16x16x32_bf16 v[216:219], a[72:75], a[32:35], v[216:219]
s_mov_b32 s39, s40
s_mov_b32 s40, s5
v_mfma_f32_16x16x32_bf16 v[216:219], a[76:79], a[36:39], v[216:219]
v_mfma_f32_16x16x32_bf16 v[220:223], a[76:79], a[44:47], v[220:223]
v_mfma_f32_16x16x32_bf16 v[220:223], a[72:75], a[40:43], v[220:223]
v_mfma_f32_16x16x32_bf16 v[224:227], a[72:75], a[48:51], v[224:227]
v_mfma_f32_16x16x32_bf16 v[224:227], a[76:79], a[52:55], v[224:227]
buffer_load_dwordx4 v8, s[12:15], s34 offen offset:1024 sc1 lds
v_mfma_f32_16x16x32_bf16 v[228:231], a[76:79], a[60:63], v[228:231]
v_mfma_f32_16x16x32_bf16 v[228:231], a[72:75], a[56:59], v[228:231]
s_waitcnt lgkmcnt(0)
v_mfma_f32_16x16x32_bf16 a[216:219], a[64:67], a[0:3], a[216:219]
ds_read_b64_tr_b16 a[72:73], v4 offset:16896
v_mfma_f32_16x16x32_bf16 a[216:219], a[68:71], a[4:7], a[216:219]
buffer_store_dwordx4 v[16:19], v15, s[12:15], s64 offen offset:384 sc1
v_mfma_f32_16x16x32_bf16 a[220:223], a[68:71], a[12:15], a[220:223]
ds_read_b64_tr_b16 a[74:75], v4 offset:20992
v_mfma_f32_16x16x32_bf16 a[220:223], a[64:67], a[8:11], a[220:223]
v_mfma_f32_16x16x32_bf16 v[232:235], a[64:67], a[16:19], v[232:235]
ds_read_b64_tr_b16 a[76:77], v4 offset:25088
v_mfma_f32_16x16x32_bf16 v[232:235], a[68:71], a[20:23], v[232:235]
buffer_load_dwordx4 v7, s[12:15], s35 offen offset:2048 sc1 lds
v_mfma_f32_16x16x32_bf16 v[236:239], a[68:71], a[28:31], v[236:239]
ds_read_b64_tr_b16 a[78:79], v4 offset:29184
v_mfma_f32_16x16x32_bf16 v[236:239], a[64:67], a[24:27], v[236:239]
v_mfma_f32_16x16x32_bf16 v[240:243], a[64:67], a[32:35], v[240:243]
v_add_u32 v3, s4, v3
v_add_u32 v4, s4, v4
v_mfma_f32_16x16x32_bf16 v[240:243], a[68:71], a[36:39], v[240:243]
v_mfma_f32_16x16x32_bf16 v[244:247], a[68:71], a[44:47], v[244:247]
v_mfma_f32_16x16x32_bf16 v[244:247], a[64:67], a[40:43], v[244:247]
v_mfma_f32_16x16x32_bf16 v[248:251], a[64:67], a[48:51], v[248:251]
buffer_load_dwordx4 v8, s[12:15], s35 offen offset:3072 sc1 lds
v_mfma_f32_16x16x32_bf16 v[248:251], a[68:71], a[52:55], v[248:251]
HOP6:
s_cbranch_execz HOP10
v_mfma_f32_16x16x32_bf16 v[252:255], a[68:71], a[60:63], v[252:255]
v_mfma_f32_16x16x32_bf16 v[252:255], a[64:67], a[56:59], v[252:255]
s_waitcnt vmcnt(12) lgkmcnt(0)
s_branch LB_G1
s_nop 0
s_nop 0
s_nop 0
s_nop 0
s_nop 0
s_nop 0
s_nop 0
s_nop 0
s_nop 0
s_nop 0
L_G1:
v_mfma_f32_16x16x32_bf16 v[252:255], a[64:67], a[56:59], v[252:255]
s_waitcnt vmcnt(8) lgkmcnt(0)
LB_G1:
s_barrier
v_mfma_f32_16x16x32_bf16 a[224:227], a[72:75], a[0:3], a[224:227]
s_cmp_eq_u32 s57, s7
ds_read_b64_tr_b16 a[64:65], v3 offset:0
v_mfma_f32_16x16x32_bf16 a[224:227], a[76:79], a[4:7], a[224:227]
s_cselect_b32 s99, s42, s41
s_cselect_b32 s100, s52, s45
ds_read_b64_tr_b16 a[66:67], v3 offset:4096
v_mfma_f32_16x16x32_bf16 a[228:231], a[76:79], a[12:15], a[228:231]
s_lshl_b32 s70, s99, 17
s_add_u32 s70, s70, s100
ds_read_b64_tr_b16 a[68:69], v3 offset:8192
v_mfma_f32_16x16x32_bf16 a[228:231], a[72:75], a[8:11], a[228:231]
s_sub_u32 s71, s70, s44
s_mov_b32 s44, s70
ds_read_b128 a[0:3], v1 offset:0
v_mfma_f32_16x16x32_bf16 a[232:235], a[72:75], a[16:19], a[232:235]
ds_read_b128 a[4:7], v2 offset:0
v_add_u32 v5, s71, v5
v_mfma_f32_16x16x32_bf16 a[232:235], a[76:79], a[20:23], a[232:235]
ds_read_b128 a[12:15], v2 offset:2048
v_add_u32 v6, s71, v6
v_mfma_f32_16x16x32_bf16 a[236:239], a[76:79], a[28:31], a[236:239]
ds_read_b128 a[8:11], v1 offset:2048
v_mfma_f32_16x16x32_bf16 a[236:239], a[72:75], a[24:27], a[236:239]
ds_read_b128 a[16:19], v1 offset:4096
v_mfma_f32_16x16x32_bf16 a[240:243], a[72:75], a[32:35], a[240:243]
s_lshl_b32 s74, s42, 7
s_sub_u32 s79, s74, s3
ds_read_b64_tr_b16 a[70:71], v3 offset:12288
v_mfma_f32_16x16x32_bf16 a[240:243], a[76:79], a[36:39], a[240:243]
s_mov_b32 s3, s74
ds_read_b128 a[20:23], v2 offset:4096
v_add_u32 v7, s79, v7
v_mfma_f32_16x16x32_bf16 a[244:247], a[76:79], a[44:47], a[244:247]
ds_read_b128 a[28:31], v2 offset:6144
v_add_u32 v8, s79, v8
v_mfma_f32_16x16x32_bf16 a[244:247], a[72:75], a[40:43], a[244:247]
s_cmp_le_u32 s57, 6
s_cselect_b32 s75, 0, 0x40000000
ds_read_b128 a[24:27], v1 offset:6144
v_mfma_f32_16x16x32_bf16 a[248:251], a[72:75], a[48:51], a[248:251]
s_mov_b32 m0, s40
ds_read_b128 a[32:35], v1 offset:8192
v_mov_b32 v16, s75
v_mfma_f32_16x16x32_bf16 a[248:251], a[76:79], a[52:55], a[248:251]
ds_read_b128 a[36:39], v2 offset:8192
v_mfma_f32_16x16x32_bf16 a[252:255], a[76:79], a[60:63], a[252:255]
buffer_load_dwordx4 v5, s[8:11], 0 offen lds
v_mfma_f32_16x16x32_bf16 a[252:255], a[72:75], a[56:59], a[252:255]
s_waitcnt lgkmcnt(5)
ds_read_b128 a[44:47], v2 offset:10240
v_mfma_f32_16x16x32_bf16 v[40:43], a[64:67], a[0:3], v[40:43]
ds_read_b128 a[40:43], v1 offset:10240
v_mfma_f32_16x16x32_bf16 v[40:43], a[68:71], a[4:7], v[40:43]
ds_read_b128 a[48:51], v1 offset:12288
v_mfma_f32_16x16x32_bf16 v[44:47], a[68:71], a[12:15], v[44:47]
ds_read_b128 a[52:55], v2 offset:12288
v_mfma_f32_16x16x32_bf16 v[44:47], a[64:67], a[8:11], v[44:47]
s_waitcnt lgkmcnt(6)
ds_read_b128 a[60:63], v2 offset:14336
v_mfma_f32_16x16x32_bf16 v[48:51], a[64:67], a[16:19], v[48:51]
ds_read_b64_tr_b16 a[72:73], v4 offset:0
v_mfma_f32_16x16x32_bf16 v[48:51], a[68:71], a[20:23], v[48:51]
ds_read_b128 a[56:59], v1 offset:14336
v_mfma_f32_16x16x32_bf16 v[52:55], a[68:71], a[28:31], v[52:55]
s_sub_u32 s79, s37, s36
ds_read_b64_tr_b16 a[74:75], v4 offset:4096
v_add_u32 v1, s79, v1
v_mfma_f32_16x16x32_bf16 v[52:55], a[64:67], a[24:27], v[52:55]
s_waitcnt lgkmcnt(8)
ds_read_b64_tr_b16 a[76:77], v4 offset:8192
v_add_u32 v2, s79, v2
v_mfma_f32_16x16x32_bf16 v[56:59], a[64:67], a[32:35], v[56:59]
s_and_b32 s73, s42, 3
s_add_u32 s73, s73, s50
ds_read_b64_tr_b16 a[78:79], v4 offset:12288
v_mfma_f32_16x16x32_bf16 v[56:59], a[68:71], a[36:39], v[56:59]
s_waitcnt lgkmcnt(8)
s_sub_u32 s4, s40, s39
v_readfirstlane_b32 s72, v10
v_mfma_f32_16x16x32_bf16 v[60:63], a[68:71], a[44:47], v[60:63]
buffer_load_dwordx4 v6, s[8:11], 0 offen offset:1024 lds
v_mfma_f32_16x16x32_bf16 v[60:63], a[64:67], a[40:43], v[60:63]
s_waitcnt lgkmcnt(6)
s_sub_u32 s72, s72, s73
v_mfma_f32_16x16x32_bf16 v[64:67], a[64:67], a[48:51], v[64:67]
buffer_load_dwordx4 v5, s[8:11], s29 offen offset:2048 lds
v_mfma_f32_16x16x32_bf16 v[64:67], a[68:71], a[52:55], v[64:67]
s_waitcnt lgkmcnt(3)
s_cmp_gt_u32 s72, 7
v_mfma_f32_16x16x32_bf16 v[68:71], a[68:71], a[60:63], v[68:71]
s_cbranch_scc1 SLOW_G1
BACK_G1:
v_mfma_f32_16x16x32_bf16 v[68:71], a[64:67], a[56:59], v[68:71]
s_waitcnt lgkmcnt(0)
v_mfma_f32_16x16x32_bf16 v[72:75], a[72:75], a[0:3], v[72:75]
ds_read_b64_tr_b16 a[64:65], v3 offset:512
v_mfma_f32_16x16x32_bf16 v[72:75], a[76:79], a[4:7], v[72:75]
v_mfma_f32_16x16x32_bf16 v[76:79], a[76:79], a[12:15], v[76:79]
ds_read_b64_tr_b16 a[66:67], v3 offset:4608
v_mfma_f32_16x16x32_bf16 v[76:79], a[72:75], a[8:11], v[76:79]
buffer_load_dwordx4 v6, s[8:11], s29 offen offset:3072 lds
v_mfma_f32_16x16x32_bf16 v[80:83], a[72:75], a[16:19], v[80:83]
ds_read_b64_tr_b16 a[68:69], v3 offset:8704
v_mfma_f32_16x16x32_bf16 v[80:83], a[76:79], a[20:23], v[80:83]
v_mfma_f32_16x16x32_bf16 v[84:87], a[76:79], a[28:31], v[84:87]
ds_read_b64_tr_b16 a[70:71], v3 offset:12800
v_mfma_f32_16x16x32_bf16 v[84:87], a[72:75], a[24:27], v[84:87]
v_mfma_f32_16x16x32_bf16 v[88:91], a[72:75], a[32:35], v[88:91]
s_add_u32 m0, s40, 0x1000
v_mfma_f32_16x16x32_bf16 v[88:91], a[76:79], a[36:39], v[88:91]
v_mfma_f32_16x16x32_bf16 v[92:95], a[76:79], a[44:47], v[92:95]
buffer_load_dwordx4 v5, s[8:11], s30 offen lds
v_mfma_f32_16x16x32_bf16 v[92:95], a[72:75], a[40:43], v[92:95]
v_mfma_f32_16x16x32_bf16 v[96:99], a[72:75], a[48:51], v[96:99]
v_mov_b32 v11, s51
v_mfma_f32_16x16x32_bf16 v[96:99], a[76:79], a[52:55], v[96:99]
buffer_store_dword v11, v16, s[16:19], s48 offen sc1
v_mfma_f32_16x16x32_bf16 v[100:103], a[76:79], a[60:63], v[100:103]
s_add_u32 s51, s51, 1
v_mfma_f32_16x16x32_bf16 v[100:103], a[72:75], a[56:59], v[100:103]
s_waitcnt lgkmcnt(0)
v_mfma_f32_16x16x32_bf16 v[104:107], a[64:67], a[0:3], v[104:107]
ds_read_b64_tr_b16 a[72:73], v4 offset:512
v_mfma_f32_16x16x32_bf16 v[104:107], a[68:71], a[4:7], v[104:107]
buffer_load_dwordx4 v6, s[8:11], s30 offen offset:1024 lds
v_mfma_f32_16x16x32_bf16 v[108:111], a[68:71], a[12:15], v[108:111]
ds_read_b64_tr_b16 a[74:75], v4 offset:4608
v_mfma_f32_16x16x32_bf16 v[108:111], a[64:67], a[8:11], v[108:111]
v_mfma_f32_16x16x32_bf16 v[112:115], a[64:67], a[16:19], v[112:115]
ds_read_b64_tr_b16 a[76:77], v4 offset:8704
v_mfma_f32_16x16x32_bf16 v[112:115], a[68:71], a[20:23], v[112:115]
v_mfma_f32_16x16x32_bf16 v[116:119], a[68:71], a[28:31], v[116:119]
ds_read_b64_tr_b16 a[78:79], v4 offset:12800
v_mfma_f32_16x16x32_bf16 v[116:119], a[64:67], a[24:27], v[116:119]
v_mfma_f32_16x16x32_bf16 v[120:123], a[64:67], a[32:35], v[120:123]
buffer_load_dwordx4 v5, s[8:11], s31 offen offset:2048 lds
v_mfma_f32_16x16x32_bf16 v[120:123], a[68:71], a[36:39], v[120:123]
v_mfma_f32_16x16x32_bf16 v[124:127], a[68:71], a[44:47], v[124:127]
s_lshr_b32 s53, s43, 2
s_lshl_b32 s53, s53, 7
s_add_u32 s53, s53, s47
v_mfma_f32_16x16x32_bf16 v[124:127], a[64:67], a[40:43], v[124:127]
buffer_load_dword v10, off, s[16:19], s53 sc1
v_mfma_f32_16x16x32_bf16 v[128:131], a[64:67], a[48:51], v[128:131]
v_mfma_f32_16x16x32_bf16 v[128:131], a[68:71], a[52:55], v[128:131]
v_mfma_f32_16x16x32_bf16 v[132:135], a[68:71], a[60:63], v[132:135]
v_mfma_f32_16x16x32_bf16 v[132:135], a[64:67], a[56:59], v[132:135]
s_waitcnt lgkmcnt(0)
v_mfma_f32_16x16x32_bf16 v[136:139], a[72:75], a[0:3], v[136:139]
ds_read_b64_tr_b16 a[64:65], v3 offset:16384
v_mfma_f32_16x16x32_bf16 v[136:139], a[76:79], a[4:7], v[136:139]
buffer_load_dwordx4 v6, s[8:11], s31 offen offset:3072 lds
v_mfma_f32_16x16x32_bf16 v[140:143], a[76:79], a[12:15], v[140:143]
ds_read_b64_tr_b16 a[66:67], v3 offset:20480
v_mfma_f32_16x16x32_bf16 v[140:143], a[72:75], a[8:11], v[140:143]
v_mfma_f32_16x16x32_bf16 v[144:147], a[72:75], a[16:19], v[144:147]
ds_read_b64_tr_b16 a[68:69], v3 offset:24576
v_mfma_f32_16x16x32_bf16 v[144:147], a[76:79], a[20:23], v[144:147]
v_mfma_f32_16x16x32_bf16 v[148:151], a[76:79], a[28:31], v[148:151]
s_mov_b32 m0, s38
ds_read_b64_tr_b16 a[70:71], v3 offset:28672
v_mfma_f32_16x16x32_bf16 v[148:151], a[72:75], a[24:27], v[148:151]
v_mfma_f32_16x16x32_bf16 v[152:155], a[72:75], a[32:35], v[152:155]
buffer_load_dwordx4 v7, s[12:15], 0 offen sc1 lds
v_mfma_f32_16x16x32_bf16 v[152:155], a[76:79], a[36:39], v[152:155]
v_mfma_f32_16x16x32_bf16 v[156:159], a[76:79], a[44:47], v[156:159]
v_mfma_f32_16x16x32_bf16 v[156:159], a[72:75], a[40:43], v[156:159]
v_mfma_f32_16x16x32_bf16 v[160:163], a[72:75], a[48:51], v[160:163]
s_add_u32 s74, s41, 1
s_mov_b32 s41, s42
s_mov_b32 s42, s43
v_mfma_f32_16x16x32_bf16 v[160:163], a[76:79], a[52:55], v[160:163]
s_mov_b32 s43, s74
v_mfma_f32_16x16x32_bf16 v[164:167], a[76:79], a[60:63], v[164:167]
v_mfma_f32_16x16x32_bf16 v[164:167], a[72:75], a[56:59], v[164:167]
s_waitcnt lgkmcnt(0)
v_mfma_f32_16x16x32_bf16 v[168:171], a[64:67], a[0:3], v[168:171]
ds_read_b64_tr_b16 a[72:73], v4 offset:16384
v_mfma_f32_16x16x32_bf16 v[168:171], a[68:71], a[4:7], v[168:171]
buffer_load_dwordx4 v8, s[12:15], 0 offen offset:1024 sc1 lds
v_mfma_f32_16x16x32_bf16 v[172:175], a[68:71], a[12:15], v[172:175]
ds_read_b64_tr_b16 a[74:75], v4 offset:20480
v_mfma_f32_16x16x32_bf16 v[172:175], a[64:67], a[8:11], v[172:175]
v_mfma_f32_16x16x32_bf16 v[176:179], a[64:67], a[16:19], v[176:179]
ds_read_b64_tr_b16 a[76:77], v4 offset:24576
v_mfma_f32_16x16x32_bf16 v[176:179], a[68:71], a[20:23], v[176:179]
v_mfma_f32_16x16x32_bf16 v[180:183], a[68:71], a[28:31], v[180:183]
ds_read_b64_tr_b16 a[78:79], v4 offset:28672
v_mfma_f32_16x16x32_bf16 v[180:183], a[64:67], a[24:27], v[180:183]
buffer_load_dwordx4 v7, s[12:15], s33 offen offset:2048 sc1 lds
v_mfma_f32_16x16x32_bf16 v[184:187], a[64:67], a[32:35], v[184:187]
v_mfma_f32_16x16x32_bf16 v[184:187], a[68:71], a[36:39], v[184:187]
v_mfma_f32_16x16x32_bf16 v[188:191], a[68:71], a[44:47], v[188:191]
v_mfma_f32_16x16x32_bf16 v[188:191], a[64:67], a[40:43], v[188:191]
v_mfma_f32_16x16x32_bf16 v[192:195], a[64:67], a[48:51], v[192:195]
v_mfma_f32_16x16x32_bf16 v[192:195], a[68:71], a[52:55], v[192:195]
v_mfma_f32_16x16x32_bf16 v[196:199], a[68:71], a[60:63], v[196:199]
buffer_load_dwordx4 v8, s[12:15], s33 offen offset:3072 sc1 lds
v_mfma_f32_16x16x32_bf16 v[196:199], a[64:67], a[56:59], v[196:199]
s_waitcnt lgkmcnt(0)
v_mfma_f32_16x16x32_bf16 v[200:203], a[72:75], a[0:3], v[200:203]
ds_read_b64_tr_b16 a[64:65], v3 offset:16896
v_mfma_f32_16x16x32_bf16 v[200:203], a[76:79], a[4:7], v[200:203]
v_mfma_f32_16x16x32_bf16 v[204:207], a[76:79], a[12:15], v[204:207]
ds_read_b64_tr_b16 a[66:67], v3 offset:20992
v_mfma_f32_16x16x32_bf16 v[204:207], a[72:75], a[8:11], v[204:207]
v_mfma_f32_16x16x32_bf16 v[208:211], a[72:75], a[16:19], v[208:211]
s_add_u32 m0, s38, 0x1000
ds_read_b64_tr_b16 a[68:69], v3 offset:25088
v_mfma_f32_16x16x32_bf16 v[208:211], a[76:79], a[20:23], v[208:211]
s_mov_b32 s5, s36
s_mov_b32 s36, s37
s_mov_b32 s37, s38
v_mfma_f32_16x16x32_bf16 v[212:215], a[76:79], a[28:31], v[212:215]
s_mov_b32 s38, s5
s_mov_b32 s5, s39
ds_read_b64_tr_b16 a[70:71], v3 offset:29184
v_mfma_f32_16x16x32_bf16 v[212:215], a[72:75], a[24:27], v[212:215]
buffer_load_dwordx4 v7, s[12:15], s34 offen sc1 lds
v_mfma_f32_16x16x32_bf16 v[216:219], a[72:75], a[32:35], v[216:219]
s_mov_b32 s39, s40
s_mov_b32 s40, s5
s_add_u32 s57, s57, 1
v_mfma_f32_16x16x32_bf16 v[216:219], a[76:79], a[36:39], v[216:219]
v_mfma_f32_16x16x32_bf16 v[220:223], a[76:79], a[44:47], v[220:223]
v_mfma_f32_16x16x32_bf16 v[220:223], a[72:75], a[40:43], v[220:223]
v_mfma_f32_16x16x32_bf16 v[224:227], a[72:75], a[48:51], v[224:227]
v_mfma_f32_16x16x32_bf16 v[224:227], a[76:79], a[52:55], v[224:227]
buffer_load_dwordx4 v8, s[12:15], s34 offen offset:1024 sc1 lds
v_mfma_f32_16x16x32_bf16 v[228:231], a[76:79], a[60:63], v[228:231]
v_mfma_f32_16x16x32_bf16 v[228:231], a[72:75], a[56:59], v[228:231]
s_waitcnt lgkmcnt(0)
v_mfma_f32_16x16x32_bf16 a[216:219], a[64:67], a[0:3], a[216:219]
ds_read_b64_tr_b16 a[72:73], v4 offset:16896
v_mfma_f32_16x16x32_bf16 a[216:219], a[68:71], a[4:7], a[216:219]
v_mfma_f32_16x16x32_bf16 a[220:223], a[68:71], a[12:15], a[220:223]
ds_read_b64_tr_b16 a[74:75], v4 offset:20992
v_mfma_f32_16x16x32_bf16 a[220:223], a[64:67], a[8:11], a[220:223]
v_mfma_f32_16x16x32_bf16 v[232:235], a[64:67], a[16:19], v[232:235]
ds_read_b64_tr_b16 a[76:77], v4 offset:25088
v_mfma_f32_16x16x32_bf16 v[232:235], a[68:71], a[20:23], v[232:235]
buffer_load_dwordx4 v7, s[12:15], s35 offen offset:2048 sc1 lds
v_mfma_f32_16x16x32_bf16 v[236:239], a[68:71], a[28:31], v[236:239]
ds_read_b64_tr_b16 a[78:79], v4 offset:29184
v_mfma_f32_16x16x32_bf16 v[236:239], a[64:67], a[24:27], v[236:239]
v_mfma_f32_16x16x32_bf16 v[240:243], a[64:67], a[32:35], v[240:243]
v_add_u32 v3, s4, v3
v_add_u32 v4, s4, v4
v_mfma_f32_16x16x32_bf16 v[240:243], a[68:71], a[36:39], v[240:243]
v_mfma_f32_16x16x32_bf16 v[244:247], a[68:71], a[44:47], v[244:247]
v_mfma_f32_16x16x32_bf16 v[244:247], a[64:67], a[40:43], v[244:247]
v_mfma_f32_16x16x32_bf16 v[248:251], a[64:67], a[48:51], v[248:251]
buffer_load_dwordx4 v8, s[12:15], s35 offen offset:3072 sc1 lds
v_mfma_f32_16x16x32_bf16 v[248:251], a[68:71], a[52:55], v[248:251]
s_cmp_lt_u32 s57, s91
v_mfma_f32_16x16x32_bf16 v[252:255], a[68:71], a[60:63], v[252:255]
s_cbranch_scc1 L_G1
s_cmp_eq_u32 s58, 1
s_cbranch_scc1 L_T14
L_TAIL:
v_mfma_f32_16x16x32_bf16 v[252:255], a[64:67], a[56:59], v[252:255]
s_waitcnt vmcnt(8) lgkmcnt(0)
s_barrier
v_mfma_f32_16x16x32_bf16 a[224:227], a[72:75], a[0:3], a[224:227]
s_and_b32 s73, s42, 3
ds_read_b128 a[0:3], v1 offset:0
ds_read_b64_tr_b16 a[64:65], v3 offset:0
v_mfma_f32_16x16x32_bf16 a[224:227], a[76:79], a[4:7], a[224:227]
s_add_u32 s73, s73, s50
ds_read_b128 a[4:7], v2 offset:0
v_readfirstlane_b32 s72, v10
v_mfma_f32_16x16x32_bf16 a[228:231], a[76:79], a[12:15], a[228:231]
s_sub_u32 s72, s72, s73
ds_read_b128 a[12:15], v2 offset:2048
ds_read_b64_tr_b16 a[66:67], v3 offset:4096
v_mfma_f32_16x16x32_bf16 a[228:231], a[72:75], a[8:11], a[228:231]
s_lshl_b32 s74, s42, 7
s_sub_u32 s79, s74, s3
ds_read_b128 a[8:11], v1 offset:2048
v_mfma_f32_16x16x32_bf16 a[232:235], a[72:75], a[16:19], a[232:235]
s_mov_b32 s3, s74
ds_read_b128 a[16:19], v1 offset:4096
ds_read_b64_tr_b16 a[68:69], v3 offset:8192
v_mfma_f32_16x16x32_bf16 a[232:235], a[76:79], a[20:23], a[232:235]
s_lshl_b32 s70, s55, 15
ds_read_b128 a[20:23], v2 offset:4096
v_add_u32 v7, s79, v7
v_mfma_f32_16x16x32_bf16 a[236:239], a[76:79], a[28:31], a[236:239]
s_lshl_b32 s71, s61, 10
ds_read_b128 a[28:31], v2 offset:6144
ds_read_b64_tr_b16 a[70:71], v3 offset:12288
v_mfma_f32_16x16x32_bf16 a[236:239], a[72:75], a[24:27], a[236:239]
s_sub_u32 s70, s70, s71
ds_read_b128 a[24:27], v1 offset:6144
v_add_u32 v8, s79, v8
v_mfma_f32_16x16x32_bf16 a[240:243], a[72:75], a[32:35], a[240:243]
s_lshr_b32 s71, s78, 6
s_sub_u32 s70, s70, s71
ds_read_b128 a[32:35], v1 offset:8192
v_mfma_f32_16x16x32_bf16 a[240:243], a[76:79], a[36:39], a[240:243]
s_add_u32 s52, s45, s70
s_lshl_b32 s70, s55, 12
ds_read_b128 a[36:39], v2 offset:8192
v_mfma_f32_16x16x32_bf16 a[244:247], a[76:79], a[44:47], a[244:247]
s_sub_u32 s76, 0, s70
s_add_u32 s77, s76, 0x4000
ds_read_b128 a[44:47], v2 offset:10240
v_mfma_f32_16x16x32_bf16 a[244:247], a[72:75], a[40:43], a[244:247]
s_sub_u32 s43, s43, 1
s_add_u32 s100, s52, 0
ds_read_b128 a[40:43], v1 offset:10240
v_mfma_f32_16x16x32_bf16 a[248:251], a[72:75], a[48:51], a[248:251]
s_lshl_b32 s70, s42, 17
s_add_u32 s70, s70, s100
ds_read_b128 a[48:51], v1 offset:12288
v_mfma_f32_16x16x32_bf16 a[248:251], a[76:79], a[52:55], a[248:251]
s_sub_u32 s71, s70, s44
s_mov_b32 s44, s70
ds_read_b128 a[52:55], v2 offset:12288
v_mfma_f32_16x16x32_bf16 a[252:255], a[76:79], a[60:63], a[252:255]
ds_read_b128 a[60:63], v2 offset:14336
v_add_u32 v5, s71, v5
v_mfma_f32_16x16x32_bf16 a[252:255], a[72:75], a[56:59], a[252:255]
s_waitcnt lgkmcnt(8)
ds_read_b128 a[56:59], v1 offset:14336
v_add_u32 v6, s71, v6
v_mfma_f32_16x16x32_bf16 v[40:43], a[64:67], a[0:3], v[40:43]
s_cmp_gt_u32 s72, 7
ds_read_b64_tr_b16 a[72:73], v4 offset:0
v_mfma_f32_16x16x32_bf16 v[40:43], a[68:71], a[4:7], v[40:43]
s_cbranch_scc1 SLOW_A13
BACK_A13:
v_mfma_f32_16x16x32_bf16 v[44:47], a[68:71], a[12:15], v[44:47]
s_add_u32 m0, s40, s76
s_sub_u32 s79, s37, s36
ds_read_b64_tr_b16 a[74:75], v4 offset:4096
v_mfma_f32_16x16x32_bf16 v[44:47], a[64:67], a[8:11], v[44:47]
s_waitcnt lgkmcnt(10)
v_add_u32 v1, s79, v1
v_add_u32 v2, s79, v2
v_mfma_f32_16x16x32_bf16 v[48:51], a[64:67], a[16:19], v[48:51]
s_lshl_b32 s7, s61, 1
s_mul_i32 s6, s55, 7168
ds_read_b64_tr_b16 a[76:77], v4 offset:8192
v_mfma_f32_16x16x32_bf16 v[48:51], a[68:71], a[20:23], v[48:51]
buffer_load_dwordx4 v5, s[8:11], 0 offen lds
v_mfma_f32_16x16x32_bf16 v[52:55], a[68:71], a[28:31], v[52:55]
s_sub_u32 s6, s39, s6
s_lshl_b32 s75, s61, 4
ds_read_b64_tr_b16 a[78:79], v4 offset:12288
v_mfma_f32_16x16x32_bf16 v[52:55], a[64:67], a[24:27], v[52:55]
s_waitcnt lgkmcnt(8)
s_sub_u32 s75, s6, s75
v_mfma_f32_16x16x32_bf16 v[56:59], a[64:67], a[32:35], v[56:59]
buffer_load_dwordx4 v6, s[8:11], 0 offen offset:1024 lds
v_mfma_f32_16x16x32_bf16 v[56:59], a[68:71], a[36:39], v[56:59]
buffer_load_dwordx4 v5, s[8:11], s29 offen offset:2048 lds
v_mfma_f32_16x16x32_bf16 v[60:63], a[68:71], a[44:47], v[60:63]
v_mfma_f32_16x16x32_bf16 v[60:63], a[64:67], a[40:43], v[60:63]
s_waitcnt lgkmcnt(4)
v_mfma_f32_16x16x32_bf16 v[64:67], a[64:67], a[48:51], v[64:67]
buffer_load_dwordx4 v6, s[8:11], s29 offen offset:3072 lds
v_mfma_f32_16x16x32_bf16 v[64:67], a[68:71], a[52:55], v[64:67]
s_mov_b32 m0, s38
v_mfma_f32_16x16x32_bf16 v[68:71], a[68:71], a[60:63], v[68:71]
v_mfma_f32_16x16x32_bf16 v[68:71], a[64:67], a[56:59], v[68:71]
s_waitcnt lgkmcnt(0)
v_mfma_f32_16x16x32_bf16 v[72:75], a[72:75], a[0:3], v[72:75]
ds_read_b64_tr_b16 a[64:65], v3 offset:512
v_mfma_f32_16x16x32_bf16 v[72:75], a[76:79], a[4:7], v[72:75]
buffer_load_dwordx4 v7, s[12:15], 0 offen sc1 lds
v_mfma_f32_16x16x32_bf16 v[76:79], a[76:79], a[12:15], v[76:79]
ds_read_b64_tr_b16 a[66:67], v3 offset:4608
v_mfma_f32_16x16x32_bf16 v[76:79], a[72:75], a[8:11], v[76:79]
buffer_load_dwordx4 v8, s[12:15], 0 offen offset:1024 sc1 lds
v_mfma_f32_16x16x32_bf16 v[80:83], a[72:75], a[16:19], v[80:83]
ds_read_b64_tr_b16 a[68:69], v3 offset:8704
v_mfma_f32_16x16x32_bf16 v[80:83], a[76:79], a[20:23], v[80:83]
buffer_load_dwordx4 v7, s[12:15], s33 offen offset:2048 sc1 lds
v_mfma_f32_16x16x32_bf16 v[84:87], a[76:79], a[28:31], v[84:87]
ds_read_b64_tr_b16 a[70:71], v3 offset:12800
v_mfma_f32_16x16x32_bf16 v[84:87], a[72:75], a[24:27], v[84:87]
v_lshrrev_b32 v16, 9, v0
v_lshlrev_b32 v16, 6, v16
v_mfma_f32_16x16x32_bf16 v[88:91], a[72:75], a[32:35], v[88:91]
buffer_load_dwordx4 v8, s[12:15], s33 offen offset:3072 sc1 lds
v_mfma_f32_16x16x32_bf16 v[88:91], a[76:79], a[36:39], v[88:91]
v_add_u32 v16, v16, v0
v_add_u32 v16, s7, v16
v_mfma_f32_16x16x32_bf16 v[92:95], a[76:79], a[44:47], v[92:95]
s_add_u32 m0, s38, 0x1000
v_and_b32 v16, 0xf0, v16
v_and_b32 v17, 0x300, v0
v_mfma_f32_16x16x32_bf16 v[92:95], a[72:75], a[40:43], v[92:95]
v_add3_u32 v10, v16, v17, s6
v_and_b32 v18, 0x70, v15
v_mfma_f32_16x16x32_bf16 v[96:99], a[72:75], a[48:51], v[96:99]
buffer_load_dwordx4 v7, s[12:15], s34 offen sc1 lds
v_mfma_f32_16x16x32_bf16 v[96:99], a[76:79], a[52:55], v[96:99]
v_lshrrev_b32 v16, 3, v0
v_and_b32 v16, 0x70, v16
v_mfma_f32_16x16x32_bf16 v[100:103], a[76:79], a[60:63], v[100:103]
v_add_u32 v16, s7, v16
v_and_b32 v17, 64, v18
v_mfma_f32_16x16x32_bf16 v[100:103], a[72:75], a[56:59], v[100:103]
s_waitcnt lgkmcnt(0)
v_lshl_add_u32 v16, v17, 1, v16
v_and_b32 v19, 16, v18
v_mfma_f32_16x16x32_bf16 v[104:107], a[64:67], a[0:3], v[104:107]
ds_read_b64_tr_b16 a[72:73], v4 offset:512
v_lshl_add_u32 v16, v19, 2, v16
v_mfma_f32_16x16x32_bf16 v[104:107], a[68:71], a[4:7], v[104:107]
buffer_load_dwordx4 v8, s[12:15], s34 offen offset:1024 sc1 lds
v_mfma_f32_16x16x32_bf16 v[108:111], a[68:71], a[12:15], v[108:111]
ds_read_b64_tr_b16 a[74:75], v4 offset:4608
v_and_b32 v16, 0xf0, v16
v_mfma_f32_16x16x32_bf16 v[108:111], a[64:67], a[8:11], v[108:111]
buffer_load_dwordx4 v7, s[12:15], s35 offen offset:2048 sc1 lds
v_mfma_f32_16x16x32_bf16 v[112:115], a[64:67], a[16:19], v[112:115]
ds_read_b64_tr_b16 a[76:77], v4 offset:8704
v_lshl_add_u32 v16, v17, 4, v16
v_mfma_f32_16x16x32_bf16 v[112:115], a[68:71], a[20:23], v[112:115]
v_lshl_add_u32 v16, v19, 5, v16
v_bfe_u32 v17, v18, 5, 1
v_mfma_f32_16x16x32_bf16 v[116:119], a[68:71], a[28:31], v[116:119]
ds_read_b64_tr_b16 a[78:79], v4 offset:12800
v_lshl_add_u32 v16, v17, 3, v16
v_mfma_f32_16x16x32_bf16 v[116:119], a[64:67], a[24:27], v[116:119]
buffer_load_dwordx4 v8, s[12:15], s35 offen offset:3072 sc1 lds
v_mfma_f32_16x16x32_bf16 v[120:123], a[64:67], a[32:35], v[120:123]
v_add_u32 v9, s75, v16
v_mfma_f32_16x16x32_bf16 v[120:123], a[68:71], a[36:39], v[120:123]
v_mfma_f32_16x16x32_bf16 v[124:127], a[68:71], a[44:47], v[124:127]
v_mfma_f32_16x16x32_bf16 v[124:127], a[64:67], a[40:43], v[124:127]
v_mfma_f32_16x16x32_bf16 v[128:131], a[64:67], a[48:51], v[128:131]
v_mfma_f32_16x16x32_bf16 v[128:131], a[68:71], a[52:55], v[128:131]
v_mfma_f32_16x16x32_bf16 v[132:135], a[68:71], a[60:63], v[132:135]
v_mfma_f32_16x16x32_bf16 v[132:135], a[64:67], a[56:59], v[132:135]
s_waitcnt vmcnt(12) lgkmcnt(0)
s_barrier
v_mfma_f32_16x16x32_bf16 v[136:139], a[72:75], a[0:3], v[136:139]
s_nop 0
ds_read_b128 a[0:3], v1 offset:0
ds_read_b64_tr_b16 a[64:65], v3 offset:16384
v_mfma_f32_16x16x32_bf16 v[136:139], a[76:79], a[4:7], v[136:139]
s_add_u32 s100, s52, 256
s_lshl_b32 s70, s42, 17
ds_read_b128 a[4:7], v2 offset:0
v_mfma_f32_16x16x32_bf16 v[140:143], a[76:79], a[12:15], v[140:143]
s_add_u32 s70, s70, s100
ds_read_b128 a[12:15], v2 offset:2048
ds_read_b64_tr_b16 a[66:67], v3 offset:20480
v_mfma_f32_16x16x32_bf16 v[140:143], a[72:75], a[8:11], v[140:143]
s_sub_u32 s71, s70, s44
s_mov_b32 s44, s70
ds_read_b128 a[8:11], v1 offset:2048
v_mfma_f32_16x16x32_bf16 v[144:147], a[72:75], a[16:19], v[144:147]
s_nop 0
ds_read_b128 a[16:19], v1 offset:4096
ds_read_b64_tr_b16 a[68:69], v3 offset:24576
v_mfma_f32_16x16x32_bf16 v[144:147], a[76:79], a[20:23], v[144:147]
ds_read_b128 a[20:23], v2 offset:4096
v_add_u32 v5, s71, v5
v_mfma_f32_16x16x32_bf16 v[148:151], a[76:79], a[28:31], v[148:151]
s_nop 0
ds_read_b128 a[28:31], v2 offset:6144
ds_read_b64_tr_b16 a[70:71], v3 offset:28672
v_mfma_f32_16x16x32_bf16 v[148:151], a[72:75], a[24:27], v[148:151]
ds_read_b128 a[24:27], v1 offset:6144
v_add_u32 v6, s71, v6
v_mfma_f32_16x16x32_bf16 v[152:155], a[72:75], a[32:35], v[152:155]
s_sub_u32 s4, s40, s39
ds_read_b128 a[32:35], v1 offset:8192
v_mov_b32_dpp v7, v38 row_newbcast:7 row_mask:0xf bank_mask:0xf
v_mfma_f32_16x16x32_bf16 v[152:155], a[76:79], a[36:39], v[152:155]
ds_read_b128 a[36:39], v2 offset:8192
v_mov_b32_dpp v8, v39 row_newbcast:7 row_mask:0xf bank_mask:0xf
v_mfma_f32_16x16x32_bf16 v[156:159], a[76:79], a[44:47], v[156:159]
ds_read_b128 a[44:47], v2 offset:10240
v_mfma_f32_16x16x32_bf16 v[156:159], a[72:75], a[40:43], v[156:159]
ds_read_b128 a[40:43], v1 offset:10240
v_mfma_f32_16x16x32_bf16 v[160:163], a[72:75], a[48:51], v[160:163]
ds_read_b128 a[48:51], v1 offset:12288
v_mfma_f32_16x16x32_bf16 v[160:163], a[76:79], a[52:55], v[160:163]
ds_read_b128 a[52:55], v2 offset:12288
v_mfma_f32_16x16x32_bf16 v[164:167], a[76:79], a[60:63], v[164:167]
ds_read_b128 a[60:63], v2 offset:14336
v_mfma_f32_16x16x32_bf16 v[164:167], a[72:75], a[56:59], v[164:167]
s_waitcnt lgkmcnt(8)
s_add_u32 m0, s40, s77
ds_read_b128 a[56:59], v1 offset:14336
v_mfma_f32_16x16x32_bf16 v[40:43], a[64:67], a[0:3], v[40:43]
s_sub_u32 s79, s38, s37
ds_read_b64_tr_b16 a[72:73], v4 offset:16384
v_add_u32 v1, s79, v1
v_mfma_f32_16x16x32_bf16 v[40:43], a[68:71], a[4:7], v[40:43]
buffer_load_dwordx4 v5, s[8:11], 0 offen lds
v_mfma_f32_16x16x32_bf16 v[44:47], a[68:71], a[12:15], v[44:47]
ds_read_b64_tr_b16 a[74:75], v4 offset:20480
v_add_u32 v2, s79, v2
v_mfma_f32_16x16x32_bf16 v[44:47], a[64:67], a[8:11], v[44:47]
s_waitcnt lgkmcnt(10)
v_mfma_f32_16x16x32_bf16 v[48:51], a[64:67], a[16:19], v[48:51]
ds_read_b64_tr_b16 a[76:77], v4 offset:24576
v_mfma_f32_16x16x32_bf16 v[48:51], a[68:71], a[20:23], v[48:51]
buffer_load_dwordx4 v6, s[8:11], 0 offen offset:1024 lds
v_mfma_f32_16x16x32_bf16 v[52:55], a[68:71], a[28:31], v[52:55]
ds_read_b64_tr_b16 a[78:79], v4 offset:28672
v_mfma_f32_16x16x32_bf16 v[52:55], a[64:67], a[24:27], v[52:55]
s_waitcnt lgkmcnt(8)
v_mfma_f32_16x16x32_bf16 v[56:59], a[64:67], a[32:35], v[56:59]
buffer_load_dwordx4 v5, s[8:11], s29 offen offset:2048 lds
v_mfma_f32_16x16x32_bf16 v[56:59], a[68:71], a[36:39], v[56:59]
v_add_u32 v3, s4, v3
v_add_u32 v4, s4, v4
v_mfma_f32_16x16x32_bf16 v[60:63], a[68:71], a[44:47], v[60:63]
buffer_load_dwordx4 v6, s[8:11], s29 offen offset:3072 lds
v_mfma_f32_16x16x32_bf16 v[60:63], a[64:67], a[40:43], v[60:63]
s_waitcnt lgkmcnt(4)
v_mfma_f32_16x16x32_bf16 v[64:67], a[64:67], a[48:51], v[64:67]
v_mfma_f32_16x16x32_bf16 v[64:67], a[68:71], a[52:55], v[64:67]
v_mfma_f32_16x16x32_bf16 v[68:71], a[68:71], a[60:63], v[68:71]
v_mfma_f32_16x16x32_bf16 v[68:71], a[64:67], a[56:59], v[68:71]
s_waitcnt vmcnt(4) lgkmcnt(0)
s_barrier
v_mfma_f32_16x16x32_bf16 v[72:75], a[72:75], a[0:3], v[72:75]
s_nop 0
ds_read_b128 a[0:3], v1 offset:0
ds_read_b64_tr_b16 a[64:65], v3 offset:0
v_mfma_f32_16x16x32_bf16 v[72:75], a[76:79], a[4:7], v[72:75]
s_add_u32 s100, s52, 256
ds_read_b128 a[4:7], v2 offset:0
v_mfma_f32_16x16x32_bf16 v[76:79], a[76:79], a[12:15], v[76:79]
s_lshl_b32 s70, s41, 17
ds_read_b128 a[12:15], v2 offset:2048
ds_read_b64_tr_b16 a[66:67], v3 offset:4096
v_mfma_f32_16x16x32_bf16 v[76:79], a[72:75], a[8:11], v[76:79]
s_add_u32 s70, s70, s100
ds_read_b128 a[8:11], v1 offset:2048
v_mfma_f32_16x16x32_bf16 v[80:83], a[72:75], a[16:19], v[80:83]
s_sub_u32 s71, s70, s44
ds_read_b128 a[16:19], v1 offset:4096
ds_read_b64_tr_b16 a[68:69], v3 offset:8192
v_mfma_f32_16x16x32_bf16 v[80:83], a[76:79], a[20:23], v[80:83]
s_mov_b32 s44, s70
ds_read_b128 a[20:23], v2 offset:4096
v_add_u32 v5, s71, v5
v_mfma_f32_16x16x32_bf16 v[84:87], a[76:79], a[28:31], v[84:87]
s_nop 0
ds_read_b128 a[28:31], v2 offset:6144
ds_read_b64_tr_b16 a[70:71], v3 offset:12288
v_mfma_f32_16x16x32_bf16 v[84:87], a[72:75], a[24:27], v[84:87]
ds_read_b128 a[24:27], v1 offset:6144
v_add_u32 v6, s71, v6
v_mfma_f32_16x16x32_bf16 v[88:91], a[72:75], a[32:35], v[88:91]
ds_read_b128 a[32:35], v1 offset:8192
v_mfma_f32_16x16x32_bf16 v[88:91], a[76:79], a[36:39], v[88:91]
ds_read_b128 a[36:39], v2 offset:8192
v_mfma_f32_16x16x32_bf16 v[92:95], a[76:79], a[44:47], v[92:95]
ds_read_b128 a[44:47], v2 offset:10240
v_mfma_f32_16x16x32_bf16 v[92:95], a[72:75], a[40:43], v[92:95]
ds_read_b128 a[40:43], v1 offset:10240
v_mfma_f32_16x16x32_bf16 v[96:99], a[72:75], a[48:51], v[96:99]
ds_read_b128 a[48:51], v1 offset:12288
v_mfma_f32_16x16x32_bf16 v[96:99], a[76:79], a[52:55], v[96:99]
ds_read_b128 a[52:55], v2 offset:12288
v_mfma_f32_16x16x32_bf16 v[100:103], a[76:79], a[60:63], v[100:103]
ds_read_b128 a[60:63], v2 offset:14336
v_mfma_f32_16x16x32_bf16 v[100:103], a[72:75], a[56:59], v[100:103]
s_waitcnt lgkmcnt(8)
ds_read_b128 a[56:59], v1 offset:14336
v_mfma_f32_16x16x32_bf16 v[40:43], a[64:67], a[0:3], v[40:43]
ds_read_b64_tr_b16 a[72:73], v4 offset:0
v_mfma_f32_16x16x32_bf16 v[40:43], a[68:71], a[4:7], v[40:43]
v_mfma_f32_16x16x32_bf16 v[44:47], a[68:71], a[12:15], v[44:47]
s_sub_u32 s79, s37, s38
ds_read_b64_tr_b16 a[74:75], v4 offset:4096
v_add_u32 v1, s79, v1
v_mfma_f32_16x16x32_bf16 v[44:47], a[64:67], a[8:11], v[44:47]
s_waitcnt lgkmcnt(10)
v_add_u32 v2, s79, v2
v_mfma_f32_16x16x32_bf16 v[48:51], a[64:67], a[16:19], v[48:51]
s_sub_u32 s4, s39, s40
ds_read_b64_tr_b16 a[76:77], v4 offset:8192
v_mfma_f32_16x16x32_bf16 v[48:51], a[68:71], a[20:23], v[48:51]
HOP7:
s_cbranch_execz HOP11
v_mfma_f32_16x16x32_bf16 v[52:55], a[68:71], a[28:31], v[52:55]
ds_read_b64_tr_b16 a[78:79], v4 offset:12288
v_mfma_f32_16x16x32_bf16 v[52:55], a[64:67], a[24:27], v[52:55]
s_waitcnt lgkmcnt(8)
v_mfma_f32_16x16x32_bf16 v[56:59], a[64:67], a[32:35], v[56:59]
v_mfma_f32_16x16x32_bf16 v[56:59], a[68:71], a[36:39], v[56:59]
v_mfma_f32_16x16x32_bf16 v[60:63], a[68:71], a[44:47], v[60:63]
v_mfma_f32_16x16x32_bf16 v[60:63], a[64:67], a[40:43], v[60:63]
s_waitcnt lgkmcnt(4)
v_mfma_f32_16x16x32_bf16 v[64:67], a[64:67], a[48:51], v[64:67]
v_mfma_f32_16x16x32_bf16 v[64:67], a[68:71], a[52:55], v[64:67]
v_mfma_f32_16x16x32_bf16 v[16:19], a[208:211], a[80:83], 0
v_mfma_f32_16x16x32_bf16 v[20:23], a[212:215], a[80:83], 0
v_mfma_f32_16x16x32_bf16 v[24:27], a[208:211], a[84:87], 0
v_mfma_f32_16x16x32_bf16 v[28:31], a[212:215], a[84:87], 0
v_mfma_f32_16x16x32_bf16 v[68:71], a[68:71], a[60:63], v[68:71]
v_mfma_f32_16x16x32_bf16 v[68:71], a[64:67], a[56:59], v[68:71]
s_waitcnt lgkmcnt(0)
v_mfma_f32_16x16x32_bf16 v[72:75], a[72:75], a[0:3], v[72:75]
ds_read_b64_tr_b16 a[64:65], v3 offset:512
v_mfma_f32_16x16x32_bf16 v[72:75], a[76:79], a[4:7], v[72:75]
v_mfma_f32_16x16x32_bf16 v[76:79], a[76:79], a[12:15], v[76:79]
ds_read_b64_tr_b16 a[66:67], v3 offset:4608
v_mfma_f32_16x16x32_bf16 v[76:79], a[72:75], a[8:11], v[76:79]
v_mfma_f32_16x16x32_bf16 v[80:83], a[72:75], a[16:19], v[80:83]
ds_read_b64_tr_b16 a[68:69], v3 offset:8704
v_mfma_f32_16x16x32_bf16 v[80:83], a[76:79], a[20:23], v[80:83]
v_mul_f32 v16, v16, v40
v_mul_f32 v17, v17, v41
v_mfma_f32_16x16x32_bf16 v[84:87], a[76:79], a[28:31], v[84:87]
ds_read_b64_tr_b16 a[70:71], v3 offset:12800
v_mul_f32 v18, v18, v42
v_mfma_f32_16x16x32_bf16 v[84:87], a[72:75], a[24:27], v[84:87]
v_mul_f32 v19, v19, v43
v_mul_f32 v20, v20, v72
v_mfma_f32_16x16x32_bf16 v[88:91], a[72:75], a[32:35], v[88:91]
v_mul_f32 v21, v21, v73
v_mul_f32 v22, v22, v74
v_mfma_f32_16x16x32_bf16 v[88:91], a[76:79], a[36:39], v[88:91]
v_mul_f32 v23, v23, v75
v_cvt_pk_bf16_f32 v16, v16, v17
v_mfma_f32_16x16x32_bf16 v[92:95], a[76:79], a[44:47], v[92:95]
v_cvt_pk_bf16_f32 v17, v18, v19
v_cvt_pk_bf16_f32 v18, v20, v21
v_mfma_f32_16x16x32_bf16 v[92:95], a[72:75], a[40:43], v[92:95]
v_cvt_pk_bf16_f32 v19, v22, v23
v_mul_f32 v24, v24, v44
v_mfma_f32_16x16x32_bf16 v[20:23], a[212:215], a[88:91], 0
ds_write_b128 v10, v[16:19] offset:0
v_mfma_f32_16x16x32_bf16 v[16:19], a[208:211], a[88:91], 0
v_mul_f32 v25, v25, v45
v_mul_f32 v26, v26, v46
v_mfma_f32_16x16x32_bf16 v[96:99], a[72:75], a[48:51], v[96:99]
v_mul_f32 v27, v27, v47
v_mul_f32 v28, v28, v76
v_mfma_f32_16x16x32_bf16 v[96:99], a[76:79], a[52:55], v[96:99]
v_mul_f32 v29, v29, v77
v_mul_f32 v30, v30, v78
v_mfma_f32_16x16x32_bf16 v[100:103], a[76:79], a[60:63], v[100:103]
v_mul_f32 v31, v31, v79
v_cvt_pk_bf16_f32 v24, v24, v25
v_mfma_f32_16x16x32_bf16 v[100:103], a[72:75], a[56:59], v[100:103]
s_waitcnt lgkmcnt(1)
v_cvt_pk_bf16_f32 v25, v26, v27
v_cvt_pk_bf16_f32 v26, v28, v29
v_mfma_f32_16x16x32_bf16 v[104:107], a[64:67], a[0:3], v[104:107]
ds_read_b64_tr_b16 a[72:73], v4 offset:512
v_cvt_pk_bf16_f32 v27, v30, v31
v_mfma_f32_16x16x32_bf16 v[28:31], a[212:215], a[92:95], 0
ds_write_b128 v10, v[24:27] offset:4096
v_mfma_f32_16x16x32_bf16 v[24:27], a[208:211], a[92:95], 0
v_mul_f32 v16, v16, v48
v_mul_f32 v17, v17, v49
v_mfma_f32_16x16x32_bf16 v[104:107], a[68:71], a[4:7], v[104:107]
v_mul_f32 v18, v18, v50
v_mul_f32 v19, v19, v51
v_mfma_f32_16x16x32_bf16 v[108:111], a[68:71], a[12:15], v[108:111]
ds_read_b64_tr_b16 a[74:75], v4 offset:4608
v_mul_f32 v20, v20, v80
v_mfma_f32_16x16x32_bf16 v[108:111], a[64:67], a[8:11], v[108:111]
v_mul_f32 v21, v21, v81
v_mul_f32 v22, v22, v82
v_mfma_f32_16x16x32_bf16 v[112:115], a[64:67], a[16:19], v[112:115]
ds_read_b64_tr_b16 a[76:77], v4 offset:8704
v_mul_f32 v23, v23, v83
v_mfma_f32_16x16x32_bf16 v[112:115], a[68:71], a[20:23], v[112:115]
v_cvt_pk_bf16_f32 v16, v16, v17
v_cvt_pk_bf16_f32 v17, v18, v19
v_mfma_f32_16x16x32_bf16 v[116:119], a[68:71], a[28:31], v[116:119]
ds_read_b64_tr_b16 a[78:79], v4 offset:12800
v_cvt_pk_bf16_f32 v18, v20, v21
v_mfma_f32_16x16x32_bf16 v[116:119], a[64:67], a[24:27], v[116:119]
v_cvt_pk_bf16_f32 v19, v22, v23
v_mul_f32 v24, v24, v52
v_mfma_f32_16x16x32_bf16 v[20:23], a[212:215], a[96:99], 0
ds_write_b128 v10, v[16:19] offset:8192
v_mfma_f32_16x16x32_bf16 v[16:19], a[208:211], a[96:99], 0
v_mul_f32 v25, v25, v53
v_mul_f32 v26, v26, v54
v_mfma_f32_16x16x32_bf16 v[120:123], a[64:67], a[32:35], v[120:123]
v_mul_f32 v27, v27, v55
v_mul_f32 v28, v28, v84
v_mfma_f32_16x16x32_bf16 v[120:123], a[68:71], a[36:39], v[120:123]
v_mul_f32 v29, v29, v85
v_mul_f32 v30, v30, v86
v_mfma_f32_16x16x32_bf16 v[124:127], a[68:71], a[44:47], v[124:127]
v_mul_f32 v31, v31, v87
v_cvt_pk_bf16_f32 v24, v24, v25
v_mfma_f32_16x16x32_bf16 v[124:127], a[64:67], a[40:43], v[124:127]
s_waitcnt lgkmcnt(4)
s_barrier
v_cvt_pk_bf16_f32 v25, v26, v27
v_mfma_f32_16x16x32_bf16 v[128:131], a[64:67], a[48:51], v[128:131]
ds_read_b64 v[36:37], v9 offset:0
v_cvt_pk_bf16_f32 v26, v28, v29
v_mfma_f32_16x16x32_bf16 v[128:131], a[68:71], a[52:55], v[128:131]
ds_read_b64 v[38:39], v9 offset:256
v_cvt_pk_bf16_f32 v27, v30, v31
v_mfma_f32_16x16x32_bf16 v[28:31], a[212:215], a[100:103], 0
ds_write_b128 v10, v[24:27] offset:12288
v_mfma_f32_16x16x32_bf16 v[24:27], a[208:211], a[100:103], 0
v_mul_f32 v16, v16, v56
v_mul_f32 v17, v17, v57
v_mfma_f32_16x16x32_bf16 v[132:135], a[68:71], a[60:63], v[132:135]
v_mul_f32 v18, v18, v58
v_mul_f32 v19, v19, v59
v_mfma_f32_16x16x32_bf16 v[132:135], a[64:67], a[56:59], v[132:135]
s_waitcnt lgkmcnt(4)
s_waitcnt vmcnt(0) lgkmcnt(3)
s_barrier
v_mul_f32 v20, v20, v88
v_mfma_f32_16x16x32_bf16 v[136:139], a[72:75], a[0:3], v[136:139]
s_add_u32 m0, s40, s76
ds_read_b64_tr_b16 a[64:65], v3 offset:16384
v_mul_f32 v21, v21, v89
v_mfma_f32_16x16x32_bf16 v[136:139], a[76:79], a[4:7], v[136:139]
buffer_load_dwordx4 v5, s[8:11], 0 offen lds
v_mfma_f32_16x16x32_bf16 v[140:143], a[76:79], a[12:15], v[140:143]
ds_read_b64_tr_b16 a[66:67], v3 offset:20480
v_mul_f32 v22, v22, v90
v_mfma_f32_16x16x32_bf16 v[140:143], a[72:75], a[8:11], v[140:143]
v_mul_f32 v23, v23, v91
v_cvt_pk_bf16_f32 v16, v16, v17
v_mfma_f32_16x16x32_bf16 v[144:147], a[72:75], a[16:19], v[144:147]
ds_read_b64_tr_b16 a[68:69], v3 offset:24576
v_cvt_pk_bf16_f32 v17, v18, v19
v_mfma_f32_16x16x32_bf16 v[144:147], a[76:79], a[20:23], v[144:147]
buffer_load_dwordx4 v6, s[8:11], 0 offen offset:1024 lds
v_mfma_f32_16x16x32_bf16 v[148:151], a[76:79], a[28:31], v[148:151]
s_waitcnt lgkmcnt(4)
buffer_store_dwordx4 v[36:39], v15, s[20:23], 0 offen offset:0 sc1
ds_read_b64_tr_b16 a[70:71], v3 offset:28672
v_cvt_pk_bf16_f32 v18, v20, v21
v_cvt_pk_bf16_f32 v19, v22, v23
v_mfma_f32_16x16x32_bf16 v[148:151], a[72:75], a[24:27], v[148:151]
ds_read_b64 v[36:37], v9 offset:4096
v_mul_f32 v24, v24, v60
v_mfma_f32_16x16x32_bf16 v[152:155], a[72:75], a[32:35], v[152:155]
ds_read_b64 v[38:39], v9 offset:4352
v_mul_f32 v25, v25, v61
v_mfma_f32_16x16x32_bf16 v[152:155], a[76:79], a[36:39], v[152:155]
buffer_load_dwordx4 v5, s[8:11], s29 offen offset:2048 lds
v_mfma_f32_16x16x32_bf16 v[156:159], a[76:79], a[44:47], v[156:159]
v_mul_f32 v26, v26, v62
v_mul_f32 v27, v27, v63
v_mfma_f32_16x16x32_bf16 v[156:159], a[72:75], a[40:43], v[156:159]
v_mfma_f32_16x16x32_bf16 v[160:163], a[72:75], a[48:51], v[160:163]
v_mfma_f32_16x16x32_bf16 v[160:163], a[76:79], a[52:55], v[160:163]
buffer_load_dwordx4 v6, s[8:11], s29 offen offset:3072 lds
v_mfma_f32_16x16x32_bf16 v[164:167], a[76:79], a[60:63], v[164:167]
v_mfma_f32_16x16x32_bf16 v[164:167], a[72:75], a[56:59], v[164:167]
s_waitcnt lgkmcnt(2)
v_mfma_f32_16x16x32_bf16 v[168:171], a[64:67], a[0:3], v[168:171]
s_waitcnt lgkmcnt(0)
buffer_store_dwordx4 v[36:39], v15, s[20:23], s33 offen offset:2048 sc1
ds_read_b64_tr_b16 a[72:73], v4 offset:16384
v_mfma_f32_16x16x32_bf16 v[168:171], a[68:71], a[4:7], v[168:171]
ds_read_b64 v[36:37], v9 offset:8192
v_mfma_f32_16x16x32_bf16 v[172:175], a[68:71], a[12:15], v[172:175]
s_nop 0
ds_read_b64_tr_b16 a[74:75], v4 offset:20480
ds_read_b64 v[38:39], v9 offset:8448
v_mfma_f32_16x16x32_bf16 v[172:175], a[64:67], a[8:11], v[172:175]
v_mfma_f32_16x16x32_bf16 v[176:179], a[64:67], a[16:19], v[176:179]
ds_read_b64_tr_b16 a[76:77], v4 offset:24576
v_mfma_f32_16x16x32_bf16 v[176:179], a[68:71], a[20:23], v[176:179]
v_mfma_f32_16x16x32_bf16 v[180:183], a[68:71], a[28:31], v[180:183]
ds_read_b64_tr_b16 a[78:79], v4 offset:28672
v_mfma_f32_16x16x32_bf16 v[180:183], a[64:67], a[24:27], v[180:183]
v_mfma_f32_16x16x32_bf16 v[184:187], a[64:67], a[32:35], v[184:187]
v_add_u32 v3, s4, v3
v_add_u32 v4, s4, v4
v_mfma_f32_16x16x32_bf16 v[184:187], a[68:71], a[36:39], v[184:187]
v_mfma_f32_16x16x32_bf16 v[188:191], a[68:71], a[44:47], v[188:191]
s_waitcnt lgkmcnt(2)
buffer_store_dwordx4 v[36:39], v15, s[20:23], s34 offen offset:0 sc1
v_mfma_f32_16x16x32_bf16 v[188:191], a[64:67], a[40:43], v[188:191]
s_barrier
v_mfma_f32_16x16x32_bf16 v[192:195], a[64:67], a[48:51], v[192:195]
ds_read_b64 v[36:37], v9 offset:12288
v_mfma_f32_16x16x32_bf16 v[20:23], a[212:215], a[104:107], 0
ds_write_b128 v10, v[16:19] offset:0
v_mfma_f32_16x16x32_bf16 v[16:19], a[208:211], a[104:107], 0
v_mul_f32 v28, v28, v92
v_mul_f32 v29, v29, v93
v_mfma_f32_16x16x32_bf16 v[192:195], a[68:71], a[52:55], v[192:195]
v_mul_f32 v30, v30, v94
v_mul_f32 v31, v31, v95
v_mfma_f32_16x16x32_bf16 v[196:199], a[68:71], a[60:63], v[196:199]
ds_read_b64 v[38:39], v9 offset:12544
v_cvt_pk_bf16_f32 v24, v24, v25
v_mfma_f32_16x16x32_bf16 v[196:199], a[64:67], a[56:59], v[196:199]
s_waitcnt lgkmcnt(3)
v_mfma_f32_16x16x32_bf16 v[200:203], a[72:75], a[0:3], v[200:203]
s_nop 0
ds_read_b128 a[0:3], v1 offset:0
ds_read_b64_tr_b16 a[64:65], v3 offset:16896
v_mfma_f32_16x16x32_bf16 v[200:203], a[76:79], a[4:7], v[200:203]
s_add_u32 s100, s52, 256
ds_read_b128 a[4:7], v2 offset:0
v_cvt_pk_bf16_f32 v25, v26, v27
v_mfma_f32_16x16x32_bf16 v[204:207], a[76:79], a[12:15], v[204:207]
s_lshl_b32 s70, s43, 17
ds_read_b128 a[12:15], v2 offset:2048
ds_read_b64_tr_b16 a[66:67], v3 offset:20992
v_mfma_f32_16x16x32_bf16 v[204:207], a[72:75], a[8:11], v[204:207]
s_add_u32 s70, s70, s100
ds_read_b128 a[8:11], v1 offset:2048
v_cvt_pk_bf16_f32 v26, v28, v29
v_mfma_f32_16x16x32_bf16 v[208:211], a[72:75], a[16:19], v[208:211]
s_sub_u32 s71, s70, s44
ds_read_b128 a[16:19], v1 offset:4096
ds_read_b64_tr_b16 a[68:69], v3 offset:25088
v_mfma_f32_16x16x32_bf16 v[208:211], a[76:79], a[20:23], v[208:211]
s_mov_b32 s44, s70
ds_read_b128 a[20:23], v2 offset:4096
v_add_u32 v5, s71, v5
v_mfma_f32_16x16x32_bf16 v[212:215], a[76:79], a[28:31], v[212:215]
s_waitcnt lgkmcnt(9)
buffer_store_dwordx4 v[36:39], v15, s[20:23], s35 offen offset:2048 sc1
ds_read_b128 a[28:31], v2 offset:6144
ds_read_b64_tr_b16 a[70:71], v3 offset:29184
v_cvt_pk_bf16_f32 v27, v30, v31
v_mfma_f32_16x16x32_bf16 v[28:31], a[212:215], a[108:111], 0
ds_write_b128 v10, v[24:27] offset:4096
v_mfma_f32_16x16x32_bf16 v[24:27], a[208:211], a[108:111], 0
v_mul_f32 v16, v16, v64
v_mul_f32 v17, v17, v65
v_mfma_f32_16x16x32_bf16 v[212:215], a[72:75], a[24:27], v[212:215]
ds_read_b128 a[24:27], v1 offset:6144
v_add_u32 v6, s71, v6
v_mfma_f32_16x16x32_bf16 v[216:219], a[72:75], a[32:35], v[216:219]
s_barrier
ds_read_b128 a[32:35], v1 offset:8192
v_mfma_f32_16x16x32_bf16 v[216:219], a[76:79], a[36:39], v[216:219]
s_nop 0
ds_read_b128 a[36:39], v2 offset:8192
ds_read_b64 v[36:37], v9 offset:0
v_mfma_f32_16x16x32_bf16 v[220:223], a[76:79], a[44:47], v[220:223]
s_sub_u32 s4, s40, s39
ds_read_b128 a[44:47], v2 offset:10240
ds_read_b64 v[38:39], v9 offset:256
v_mfma_f32_16x16x32_bf16 v[220:223], a[72:75], a[40:43], v[220:223]
ds_read_b128 a[40:43], v1 offset:10240
v_mul_f32 v18, v18, v66
v_mfma_f32_16x16x32_bf16 v[224:227], a[72:75], a[48:51], v[224:227]
ds_read_b128 a[48:51], v1 offset:12288
v_mul_f32 v19, v19, v67
v_mfma_f32_16x16x32_bf16 v[224:227], a[76:79], a[52:55], v[224:227]
ds_read_b128 a[52:55], v2 offset:12288
v_mul_f32 v20, v20, v96
v_mfma_f32_16x16x32_bf16 v[228:231], a[76:79], a[60:63], v[228:231]
ds_read_b128 a[60:63], v2 offset:14336
v_mul_f32 v21, v21, v97
v_mfma_f32_16x16x32_bf16 v[228:231], a[72:75], a[56:59], v[228:231]
s_waitcnt lgkmcnt(11)
ds_read_b128 a[56:59], v1 offset:14336
v_mul_f32 v22, v22, v98
v_mfma_f32_16x16x32_bf16 v[104:107], a[64:67], a[0:3], v[104:107]
ds_read_b64_tr_b16 a[72:73], v4 offset:16896
v_mul_f32 v23, v23, v99
v_mfma_f32_16x16x32_bf16 v[104:107], a[68:71], a[4:7], v[104:107]
v_cvt_pk_bf16_f32 v16, v16, v17
v_cvt_pk_bf16_f32 v17, v18, v19
v_mfma_f32_16x16x32_bf16 v[108:111], a[68:71], a[12:15], v[108:111]
s_sub_u32 s79, s36, s37
ds_read_b64_tr_b16 a[74:75], v4 offset:20992
v_add_u32 v1, s79, v1
v_mfma_f32_16x16x32_bf16 v[108:111], a[64:67], a[8:11], v[108:111]
s_waitcnt lgkmcnt(12)
s_waitcnt lgkmcnt(7)
buffer_store_dwordx4 v[36:39], v15, s[20:23], s62 offen offset:0 sc1
v_add_u32 v2, s79, v2
v_cvt_pk_bf16_f32 v18, v20, v21
v_cvt_pk_bf16_f32 v19, v22, v23
v_mfma_f32_16x16x32_bf16 v[20:23], a[212:215], a[112:115], 0
ds_write_b128 v10, v[16:19] offset:8192
v_mfma_f32_16x16x32_bf16 v[16:19], a[208:211], a[112:115], 0
v_mul_f32 v24, v24, v68
v_mul_f32 v25, v25, v69
v_mfma_f32_16x16x32_bf16 v[112:115], a[64:67], a[16:19], v[112:115]
s_barrier
ds_read_b64_tr_b16 a[76:77], v4 offset:25088
v_mfma_f32_16x16x32_bf16 v[112:115], a[68:71], a[20:23], v[112:115]
ds_read_b64 v[36:37], v9 offset:4096
v_mul_f32 v26, v26, v70
v_mfma_f32_16x16x32_bf16 v[116:119], a[68:71], a[28:31], v[116:119]
s_nop 0
ds_read_b64_tr_b16 a[78:79], v4 offset:29184
ds_read_b64 v[38:39], v9 offset:4352
v_mfma_f32_16x16x32_bf16 v[116:119], a[64:67], a[24:27], v[116:119]
s_waitcnt lgkmcnt(11)
v_mul_f32 v27, v27, v71
v_mul_f32 v28, v28, v100
v_mfma_f32_16x16x32_bf16 v[120:123], a[64:67], a[32:35], v[120:123]
v_add_u32 v3, s4, v3
v_add_u32 v4, s4, v4
v_mfma_f32_16x16x32_bf16 v[120:123], a[68:71], a[36:39], v[120:123]
v_mul_f32 v29, v29, v101
v_mul_f32 v30, v30, v102
v_mfma_f32_16x16x32_bf16 v[124:127], a[68:71], a[44:47], v[124:127]
v_mul_f32 v31, v31, v103
v_cvt_pk_bf16_f32 v24, v24, v25
v_mfma_f32_16x16x32_bf16 v[124:127], a[64:67], a[40:43], v[124:127]
s_waitcnt lgkmcnt(7)
v_cvt_pk_bf16_f32 v25, v26, v27
v_cvt_pk_bf16_f32 v26, v28, v29
v_mfma_f32_16x16x32_bf16 v[128:131], a[64:67], a[48:51], v[128:131]
v_cvt_pk_bf16_f32 v27, v30, v31
v_mfma_f32_16x16x32_bf16 v[28:31], a[212:215], a[116:119], 0
ds_write_b128 v10, v[24:27] offset:12288
v_mfma_f32_16x16x32_bf16 v[24:27], a[208:211], a[116:119], 0
v_mfma_f32_16x16x32_bf16 v[128:131], a[68:71], a[52:55], v[128:131]
v_mfma_f32_16x16x32_bf16 v[132:135], a[68:71], a[60:63], v[132:135]
s_waitcnt lgkmcnt(1)
buffer_store_dwordx4 v[36:39], v15, s[20:23], s63 offen offset:0 sc1
v_mfma_f32_16x16x32_bf16 v[132:135], a[64:67], a[56:59], v[132:135]
s_waitcnt vmcnt(5)
s_barrier
v_mfma_f32_16x16x32_bf16 v[136:139], a[72:75], a[0:3], v[136:139]
s_add_u32 m0, s39, s77
ds_read_b64_tr_b16 a[64:65], v3 offset:0
v_mfma_f32_16x16x32_bf16 v[136:139], a[76:79], a[4:7], v[136:139]
buffer_load_dwordx4 v5, s[8:11], 0 offen lds
v_mfma_f32_16x16x32_bf16 v[140:143], a[76:79], a[12:15], v[140:143]
s_waitcnt lgkmcnt(1)
s_barrier
ds_read_b64_tr_b16 a[66:67], v3 offset:4096
v_mfma_f32_16x16x32_bf16 v[140:143], a[72:75], a[8:11], v[140:143]
ds_read_b64 v[36:37], v9 offset:8192
v_mfma_f32_16x16x32_bf16 v[144:147], a[72:75], a[16:19], v[144:147]
s_nop 0
ds_read_b64_tr_b16 a[68:69], v3 offset:8192
ds_read_b64 v[38:39], v9 offset:8448
v_mfma_f32_16x16x32_bf16 v[144:147], a[76:79], a[20:23], v[144:147]
buffer_load_dwordx4 v6, s[8:11], 0 offen offset:1024 lds
v_mfma_f32_16x16x32_bf16 v[148:151], a[76:79], a[28:31], v[148:151]
ds_read_b64_tr_b16 a[70:71], v3 offset:12288
v_mul_f32 v16, v16, v104
v_mfma_f32_16x16x32_bf16 v[148:151], a[72:75], a[24:27], v[148:151]
v_mul_f32 v17, v17, v105
v_mul_f32 v18, v18, v106
v_mfma_f32_16x16x32_bf16 v[152:155], a[72:75], a[32:35], v[152:155]
v_mul_f32 v19, v19, v107
v_mul_f32 v20, v20, v136
v_mfma_f32_16x16x32_bf16 v[152:155], a[76:79], a[36:39], v[152:155]
buffer_load_dwordx4 v5, s[8:11], s29 offen offset:2048 lds
v_mfma_f32_16x16x32_bf16 v[156:159], a[76:79], a[44:47], v[156:159]
v_mul_f32 v21, v21, v137
v_mfma_f32_16x16x32_bf16 v[156:159], a[72:75], a[40:43], v[156:159]
s_sub_u32 s73, s37, s39
v_add_u32 v10, s73, v10
v_mul_f32 v22, v22, v138
v_mfma_f32_16x16x32_bf16 v[160:163], a[72:75], a[48:51], v[160:163]
s_waitcnt lgkmcnt(1)
buffer_store_dwordx4 v[36:39], v15, s[20:23], s64 offen offset:0 sc1
v_mul_f32 v23, v23, v139
v_cvt_pk_bf16_f32 v16, v16, v17
v_cvt_pk_bf16_f32 v17, v18, v19
v_mfma_f32_16x16x32_bf16 v[160:163], a[76:79], a[52:55], v[160:163]
buffer_load_dwordx4 v6, s[8:11], s29 offen offset:3072 lds
v_mfma_f32_16x16x32_bf16 v[164:167], a[76:79], a[60:63], v[164:167]
ds_read_b64 v[36:37], v9 offset:12288
v_cvt_pk_bf16_f32 v18, v20, v21
v_mfma_f32_16x16x32_bf16 v[164:167], a[72:75], a[56:59], v[164:167]
s_waitcnt lgkmcnt(1)
ds_read_b64 v[38:39], v9 offset:12544
v_cvt_pk_bf16_f32 v19, v22, v23
v_mfma_f32_16x16x32_bf16 v[20:23], a[212:215], a[120:123], 0
ds_write_b128 v10, v[16:19] offset:0
v_mfma_f32_16x16x32_bf16 v[16:19], a[208:211], a[120:123], 0
v_mul_f32 v24, v24, v108
v_mul_f32 v25, v25, v109
v_mfma_f32_16x16x32_bf16 v[168:171], a[64:67], a[0:3], v[168:171]
ds_read_b64_tr_b16 a[72:73], v4 offset:0
v_mul_f32 v26, v26, v110
v_mfma_f32_16x16x32_bf16 v[168:171], a[68:71], a[4:7], v[168:171]
v_mul_f32 v27, v27, v111
v_mul_f32 v28, v28, v140
v_mfma_f32_16x16x32_bf16 v[172:175], a[68:71], a[12:15], v[172:175]
s_sub_u32 s4, s39, s40
ds_read_b64_tr_b16 a[74:75], v4 offset:4096
v_mul_f32 v29, v29, v141
v_mfma_f32_16x16x32_bf16 v[172:175], a[64:67], a[8:11], v[172:175]
v_mul_f32 v30, v30, v142
v_mul_f32 v31, v31, v143
v_mfma_f32_16x16x32_bf16 v[176:179], a[64:67], a[16:19], v[176:179]
ds_read_b64_tr_b16 a[76:77], v4 offset:8192
v_cvt_pk_bf16_f32 v24, v24, v25
v_mfma_f32_16x16x32_bf16 v[176:179], a[68:71], a[20:23], v[176:179]
v_cvt_pk_bf16_f32 v25, v26, v27
v_cvt_pk_bf16_f32 v26, v28, v29
v_mfma_f32_16x16x32_bf16 v[180:183], a[68:71], a[28:31], v[180:183]
ds_read_b64_tr_b16 a[78:79], v4 offset:12288
v_cvt_pk_bf16_f32 v27, v30, v31
v_mfma_f32_16x16x32_bf16 v[28:31], a[212:215], a[124:127], 0
ds_write_b128 v10, v[24:27] offset:4096
v_mfma_f32_16x16x32_bf16 v[24:27], a[208:211], a[124:127], 0
v_mul_f32 v16, v16, v112
v_mul_f32 v17, v17, v113
v_mfma_f32_16x16x32_bf16 v[180:183], a[64:67], a[24:27], v[180:183]
s_waitcnt lgkmcnt(6)
buffer_store_dwordx4 v[36:39], v15, s[20:23], s101 offen offset:0 sc1
v_mul_f32 v18, v18, v114
v_mul_f32 v19, v19, v115
v_mul_f32 v20, v20, v144
v_mfma_f32_16x16x32_bf16 v[184:187], a[64:67], a[32:35], v[184:187]
v_mul_f32 v21, v21, v145
v_mul_f32 v22, v22, v146
v_mfma_f32_16x16x32_bf16 v[184:187], a[68:71], a[36:39], v[184:187]
v_mul_f32 v23, v23, v147
v_cvt_pk_bf16_f32 v16, v16, v17
v_mfma_f32_16x16x32_bf16 v[188:191], a[68:71], a[44:47], v[188:191]
v_cvt_pk_bf16_f32 v17, v18, v19
v_cvt_pk_bf16_f32 v18, v20, v21
v_mfma_f32_16x16x32_bf16 v[188:191], a[64:67], a[40:43], v[188:191]
s_sub_u32 s72, s37, s39
v_add_u32 v9, s72, v9
v_cvt_pk_bf16_f32 v19, v22, v23
v_mfma_f32_16x16x32_bf16 v[20:23], a[212:215], a[128:131], 0
ds_write_b128 v10, v[16:19] offset:8192
v_mfma_f32_16x16x32_bf16 v[16:19], a[208:211], a[128:131], 0
v_mul_f32 v24, v24, v116
v_mul_f32 v25, v25, v117
v_mfma_f32_16x16x32_bf16 v[192:195], a[64:67], a[48:51], v[192:195]
s_waitcnt lgkmcnt(1)
s_barrier
v_mul_f32 v26, v26, v118
v_mfma_f32_16x16x32_bf16 v[192:195], a[68:71], a[52:55], v[192:195]
ds_read_b64 v[36:37], v9 offset:0
v_mul_f32 v27, v27, v119
v_mfma_f32_16x16x32_bf16 v[196:199], a[68:71], a[60:63], v[196:199]
ds_read_b64 v[38:39], v9 offset:256
v_mul_f32 v28, v28, v148
v_mfma_f32_16x16x32_bf16 v[196:199], a[64:67], a[56:59], v[196:199]
v_mul_f32 v29, v29, v149
v_mul_f32 v30, v30, v150
v_mfma_f32_16x16x32_bf16 v[200:203], a[72:75], a[0:3], v[200:203]
ds_read_b64_tr_b16 a[64:65], v3 offset:512
v_mul_f32 v31, v31, v151
v_mfma_f32_16x16x32_bf16 v[200:203], a[76:79], a[4:7], v[200:203]
v_cvt_pk_bf16_f32 v24, v24, v25
v_cvt_pk_bf16_f32 v25, v26, v27
v_mfma_f32_16x16x32_bf16 v[204:207], a[76:79], a[12:15], v[204:207]
ds_read_b64_tr_b16 a[66:67], v3 offset:4608
v_cvt_pk_bf16_f32 v26, v28, v29
v_mfma_f32_16x16x32_bf16 v[204:207], a[72:75], a[8:11], v[204:207]
v_cvt_pk_bf16_f32 v27, v30, v31
v_mul_f32 v16, v16, v120
v_mfma_f32_16x16x32_bf16 v[28:31], a[212:215], a[132:135], 0
ds_write_b128 v10, v[24:27] offset:12288
v_mfma_f32_16x16x32_bf16 v[24:27], a[208:211], a[132:135], 0
v_mul_f32 v17, v17, v121
v_mul_f32 v18, v18, v122
v_mfma_f32_16x16x32_bf16 v[208:211], a[72:75], a[16:19], v[208:211]
ds_read_b64_tr_b16 a[68:69], v3 offset:8704
v_mul_f32 v19, v19, v123
v_mfma_f32_16x16x32_bf16 v[208:211], a[76:79], a[20:23], v[208:211]
v_mul_f32 v20, v20, v152
v_mul_f32 v21, v21, v153
v_mfma_f32_16x16x32_bf16 v[212:215], a[76:79], a[28:31], v[212:215]
s_waitcnt lgkmcnt(4)
buffer_store_dwordx4 v[36:39], v15, s[20:23], 0 offen offset:128 sc1
ds_read_b64_tr_b16 a[70:71], v3 offset:12800
v_mul_f32 v22, v22, v154
v_mul_f32 v23, v23, v155
v_mfma_f32_16x16x32_bf16 v[212:215], a[72:75], a[24:27], v[212:215]
ds_read_b64 v[36:37], v9 offset:4096
v_cvt_pk_bf16_f32 v16, v16, v17
v_mfma_f32_16x16x32_bf16 v[216:219], a[72:75], a[32:35], v[216:219]
ds_read_b64 v[38:39], v9 offset:4352
v_cvt_pk_bf16_f32 v17, v18, v19
v_mfma_f32_16x16x32_bf16 v[216:219], a[76:79], a[36:39], v[216:219]
v_cvt_pk_bf16_f32 v18, v20, v21
v_cvt_pk_bf16_f32 v19, v22, v23
v_mfma_f32_16x16x32_bf16 v[20:23], a[212:215], a[136:139], 0
ds_write_b128 v10, v[16:19] offset:16384
v_mfma_f32_16x16x32_bf16 v[16:19], a[208:211], a[136:139], 0
v_mul_f32 v24, v24, v124
v_mul_f32 v25, v25, v125
v_mfma_f32_16x16x32_bf16 v[220:223], a[76:79], a[44:47], v[220:223]
v_mul_f32 v26, v26, v126
v_mul_f32 v27, v27, v127
v_mfma_f32_16x16x32_bf16 v[220:223], a[72:75], a[40:43], v[220:223]
v_mul_f32 v28, v28, v156
v_mul_f32 v29, v29, v157
v_mfma_f32_16x16x32_bf16 v[224:227], a[72:75], a[48:51], v[224:227]
v_mul_f32 v30, v30, v158
v_mul_f32 v31, v31, v159
v_mfma_f32_16x16x32_bf16 v[224:227], a[76:79], a[52:55], v[224:227]
v_cvt_pk_bf16_f32 v24, v24, v25
v_cvt_pk_bf16_f32 v25, v26, v27
v_mfma_f32_16x16x32_bf16 v[228:231], a[76:79], a[60:63], v[228:231]
v_cvt_pk_bf16_f32 v26, v28, v29
v_cvt_pk_bf16_f32 v27, v30, v31
v_mfma_f32_16x16x32_bf16 v[28:31], a[212:215], a[140:143], 0
ds_write_b128 v10, v[24:27] offset:20480
v_mfma_f32_16x16x32_bf16 v[24:27], a[208:211], a[140:143], 0
v_mul_f32 v16, v16, v128
v_mul_f32 v17, v17, v129
v_mfma_f32_16x16x32_bf16 v[228:231], a[72:75], a[56:59], v[228:231]
s_waitcnt lgkmcnt(4)
v_mul_f32 v18, v18, v130
v_mul_f32 v19, v19, v131
v_mfma_f32_16x16x32_bf16 a[216:219], a[64:67], a[0:3], a[216:219]
s_waitcnt lgkmcnt(2)
buffer_store_dwordx4 v[36:39], v15, s[20:23], s33 offen offset:2176 sc1
ds_read_b64_tr_b16 a[72:73], v4 offset:512
v_mul_f32 v20, v20, v160
v_mul_f32 v21, v21, v161
v_mfma_f32_16x16x32_bf16 a[216:219], a[68:71], a[4:7], a[216:219]
s_waitcnt lgkmcnt(2)
s_barrier
v_mul_f32 v22, v22, v162
v_mfma_f32_16x16x32_bf16 a[220:223], a[68:71], a[12:15], a[220:223]
s_nop 0
ds_read_b64_tr_b16 a[74:75], v4 offset:4608
ds_read_b64 v[36:37], v9 offset:8192
v_mfma_f32_16x16x32_bf16 a[220:223], a[64:67], a[8:11], a[220:223]
ds_read_b64 v[38:39], v9 offset:8448
v_mul_f32 v23, v23, v163
v_mfma_f32_16x16x32_bf16 v[232:235], a[64:67], a[16:19], v[232:235]
ds_read_b64_tr_b16 a[76:77], v4 offset:8704
v_cvt_pk_bf16_f32 v16, v16, v17
v_mfma_f32_16x16x32_bf16 v[232:235], a[68:71], a[20:23], v[232:235]
v_cvt_pk_bf16_f32 v17, v18, v19
v_cvt_pk_bf16_f32 v18, v20, v21
v_mfma_f32_16x16x32_bf16 v[236:239], a[68:71], a[28:31], v[236:239]
ds_read_b64_tr_b16 a[78:79], v4 offset:12800
v_cvt_pk_bf16_f32 v19, v22, v23
v_mfma_f32_16x16x32_bf16 v[20:23], a[212:215], a[144:147], 0
ds_write_b128 v10, v[16:19] offset:24576
v_mfma_f32_16x16x32_bf16 v[16:19], a[208:211], a[144:147], 0
v_mul_f32 v24, v24, v132
v_mul_f32 v25, v25, v133
v_mfma_f32_16x16x32_bf16 v[236:239], a[64:67], a[24:27], v[236:239]
v_mul_f32 v26, v26, v134
v_mul_f32 v27, v27, v135
v_mfma_f32_16x16x32_bf16 v[240:243], a[64:67], a[32:35], v[240:243]
v_add_u32 v3, s4, v3
v_add_u32 v4, s4, v4
v_mfma_f32_16x16x32_bf16 v[240:243], a[68:71], a[36:39], v[240:243]
v_mul_f32 v28, v28, v164
v_mul_f32 v29, v29, v165
v_mfma_f32_16x16x32_bf16 v[244:247], a[68:71], a[44:47], v[244:247]
v_mul_f32 v30, v30, v166
v_mul_f32 v31, v31, v167
v_mfma_f32_16x16x32_bf16 v[244:247], a[64:67], a[40:43], v[244:247]
s_waitcnt lgkmcnt(3)
buffer_store_dwordx4 v[36:39], v15, s[20:23], s34 offen offset:128 sc1
v_cvt_pk_bf16_f32 v24, v24, v25
v_cvt_pk_bf16_f32 v25, v26, v27
v_cvt_pk_bf16_f32 v26, v28, v29
v_mfma_f32_16x16x32_bf16 v[248:251], a[64:67], a[48:51], v[248:251]
ds_read_b64 v[36:37], v9 offset:12288
v_cvt_pk_bf16_f32 v27, v30, v31
v_mfma_f32_16x16x32_bf16 v[28:31], a[212:215], a[148:151], 0
ds_write_b128 v10, v[24:27] offset:28672
v_mfma_f32_16x16x32_bf16 v[24:27], a[208:211], a[148:151], 0
v_mfma_f32_16x16x32_bf16 v[248:251], a[68:71], a[52:55], v[248:251]
v_mfma_f32_16x16x32_bf16 v[252:255], a[68:71], a[60:63], v[252:255]
ds_read_b64 v[38:39], v9 offset:12544
v_mfma_f32_16x16x32_bf16 v[252:255], a[64:67], a[56:59], v[252:255]
s_waitcnt vmcnt(4) lgkmcnt(0)
s_barrier
v_mfma_f32_16x16x32_bf16 a[224:227], a[72:75], a[0:3], a[224:227]
s_nop 0
ds_read_b128 a[0:3], v1 offset:0
ds_read_b64_tr_b16 a[64:65], v3 offset:16384
v_mfma_f32_16x16x32_bf16 a[224:227], a[76:79], a[4:7], a[224:227]
ds_read_b128 a[4:7], v2 offset:0
v_mfma_f32_16x16x32_bf16 a[228:231], a[76:79], a[12:15], a[228:231]
s_nop 0
ds_read_b128 a[12:15], v2 offset:2048
ds_read_b64_tr_b16 a[66:67], v3 offset:20480
v_mfma_f32_16x16x32_bf16 a[228:231], a[72:75], a[8:11], a[228:231]
ds_read_b128 a[8:11], v1 offset:2048
v_mfma_f32_16x16x32_bf16 a[232:235], a[72:75], a[16:19], a[232:235]
s_nop 0
ds_read_b128 a[16:19], v1 offset:4096
ds_read_b64_tr_b16 a[68:69], v3 offset:24576
v_mfma_f32_16x16x32_bf16 a[232:235], a[76:79], a[20:23], a[232:235]
ds_read_b128 a[20:23], v2 offset:4096
v_mfma_f32_16x16x32_bf16 a[236:239], a[76:79], a[28:31], a[236:239]
buffer_store_dwordx4 v[36:39], v15, s[20:23], s35 offen offset:2176 sc1
ds_read_b128 a[28:31], v2 offset:6144
ds_read_b64_tr_b16 a[70:71], v3 offset:28672
v_mfma_f32_16x16x32_bf16 a[236:239], a[72:75], a[24:27], a[236:239]
HOP8:
s_cbranch_execz HOP12
s_nop 0
ds_read_b128 a[24:27], v1 offset:6144
ds_read_b64 v[36:37], v9 offset:16384
v_mfma_f32_16x16x32_bf16 a[240:243], a[72:75], a[32:35], a[240:243]
s_nop 0
ds_read_b128 a[32:35], v1 offset:8192
ds_read_b64 v[38:39], v9 offset:16640
v_mfma_f32_16x16x32_bf16 a[240:243], a[76:79], a[36:39], a[240:243]
ds_read_b128 a[36:39], v2 offset:8192
v_mfma_f32_16x16x32_bf16 a[244:247], a[76:79], a[44:47], a[244:247]
ds_read_b128 a[44:47], v2 offset:10240
v_mfma_f32_16x16x32_bf16 a[244:247], a[72:75], a[40:43], a[244:247]
ds_read_b128 a[40:43], v1 offset:10240
v_mfma_f32_16x16x32_bf16 a[248:251], a[72:75], a[48:51], a[248:251]
ds_read_b128 a[48:51], v1 offset:12288
v_mfma_f32_16x16x32_bf16 a[248:251], a[76:79], a[52:55], a[248:251]
ds_read_b128 a[52:55], v2 offset:12288
v_mfma_f32_16x16x32_bf16 a[252:255], a[76:79], a[60:63], a[252:255]
ds_read_b128 a[60:63], v2 offset:14336
v_mfma_f32_16x16x32_bf16 a[252:255], a[72:75], a[56:59], a[252:255]
s_waitcnt lgkmcnt(10)
ds_read_b128 a[56:59], v1 offset:14336
v_mfma_f32_16x16x32_bf16 v[168:171], a[64:67], a[0:3], v[168:171]
s_waitcnt lgkmcnt(7)
buffer_store_dwordx4 v[36:39], v15, s[20:23], s62 offen offset:128 sc1
ds_read_b64_tr_b16 a[72:73], v4 offset:16384
v_mfma_f32_16x16x32_bf16 v[168:171], a[68:71], a[4:7], v[168:171]
ds_read_b64 v[36:37], v9 offset:20480
v_mfma_f32_16x16x32_bf16 v[172:175], a[68:71], a[12:15], v[172:175]
s_sub_u32 s79, s38, s36
ds_read_b64_tr_b16 a[74:75], v4 offset:20480
v_add_u32 v1, s79, v1
v_mfma_f32_16x16x32_bf16 v[172:175], a[64:67], a[8:11], v[172:175]
ds_read_b64 v[38:39], v9 offset:20736
v_add_u32 v2, s79, v2
v_mfma_f32_16x16x32_bf16 v[176:179], a[64:67], a[16:19], v[176:179]
s_sub_u32 s4, s40, s39
ds_read_b64_tr_b16 a[76:77], v4 offset:24576
v_mfma_f32_16x16x32_bf16 v[176:179], a[68:71], a[20:23], v[176:179]
v_mfma_f32_16x16x32_bf16 v[180:183], a[68:71], a[28:31], v[180:183]
ds_read_b64_tr_b16 a[78:79], v4 offset:28672
v_mfma_f32_16x16x32_bf16 v[180:183], a[64:67], a[24:27], v[180:183]
s_waitcnt lgkmcnt(10)
v_mfma_f32_16x16x32_bf16 v[184:187], a[64:67], a[32:35], v[184:187]
v_mfma_f32_16x16x32_bf16 v[184:187], a[68:71], a[36:39], v[184:187]
v_mfma_f32_16x16x32_bf16 v[188:191], a[68:71], a[44:47], v[188:191]
v_mfma_f32_16x16x32_bf16 v[188:191], a[64:67], a[40:43], v[188:191]
s_waitcnt lgkmcnt(6)
s_waitcnt lgkmcnt(2)
buffer_store_dwordx4 v[36:39], v15, s[20:23], s63 offen offset:128 sc1
v_mfma_f32_16x16x32_bf16 v[192:195], a[64:67], a[48:51], v[192:195]
ds_read_b64 v[36:37], v9 offset:24576
v_mfma_f32_16x16x32_bf16 v[192:195], a[68:71], a[52:55], v[192:195]
ds_read_b64 v[38:39], v9 offset:24832
v_mfma_f32_16x16x32_bf16 v[196:199], a[68:71], a[60:63], v[196:199]
v_mfma_f32_16x16x32_bf16 v[196:199], a[64:67], a[56:59], v[196:199]
s_waitcnt lgkmcnt(2)
s_barrier
v_mfma_f32_16x16x32_bf16 v[200:203], a[72:75], a[0:3], v[200:203]
ds_read_b64_tr_b16 a[64:65], v3 offset:16896
v_mfma_f32_16x16x32_bf16 v[200:203], a[76:79], a[4:7], v[200:203]
v_mfma_f32_16x16x32_bf16 v[204:207], a[76:79], a[12:15], v[204:207]
ds_read_b64_tr_b16 a[66:67], v3 offset:20992
v_mfma_f32_16x16x32_bf16 v[204:207], a[72:75], a[8:11], v[204:207]
v_mfma_f32_16x16x32_bf16 v[208:211], a[72:75], a[16:19], v[208:211]
ds_read_b64_tr_b16 a[68:69], v3 offset:25088
v_mfma_f32_16x16x32_bf16 v[208:211], a[76:79], a[20:23], v[208:211]
s_waitcnt lgkmcnt(3)
buffer_store_dwordx4 v[36:39], v15, s[20:23], s64 offen offset:128 sc1
v_mul_f32 v16, v16, v168
v_mul_f32 v17, v17, v169
v_mul_f32 v18, v18, v170
v_mfma_f32_16x16x32_bf16 v[212:215], a[76:79], a[28:31], v[212:215]
s_nop 0
ds_read_b64_tr_b16 a[70:71], v3 offset:29184
ds_read_b64 v[36:37], v9 offset:28672
v_mfma_f32_16x16x32_bf16 v[212:215], a[72:75], a[24:27], v[212:215]
ds_read_b64 v[38:39], v9 offset:28928
v_mul_f32 v19, v19, v171
v_mfma_f32_16x16x32_bf16 v[216:219], a[72:75], a[32:35], v[216:219]
v_mul_f32 v20, v20, v200
v_mul_f32 v21, v21, v201
v_mfma_f32_16x16x32_bf16 v[216:219], a[76:79], a[36:39], v[216:219]
s_sub_u32 s73, s36, s37
v_add_u32 v10, s73, v10
v_mul_f32 v22, v22, v202
v_mfma_f32_16x16x32_bf16 v[220:223], a[76:79], a[44:47], v[220:223]
v_mul_f32 v23, v23, v203
v_cvt_pk_bf16_f32 v16, v16, v17
v_mfma_f32_16x16x32_bf16 v[220:223], a[72:75], a[40:43], v[220:223]
v_cvt_pk_bf16_f32 v17, v18, v19
v_cvt_pk_bf16_f32 v18, v20, v21
v_mfma_f32_16x16x32_bf16 v[224:227], a[72:75], a[48:51], v[224:227]
v_cvt_pk_bf16_f32 v19, v22, v23
v_mul_f32 v24, v24, v172
v_mfma_f32_16x16x32_bf16 v[20:23], a[212:215], a[152:155], 0
ds_write_b128 v10, v[16:19] offset:0
v_mfma_f32_16x16x32_bf16 v[16:19], a[208:211], a[152:155], 0
v_mul_f32 v25, v25, v173
v_mul_f32 v26, v26, v174
v_mfma_f32_16x16x32_bf16 v[224:227], a[76:79], a[52:55], v[224:227]
v_mul_f32 v27, v27, v175
v_mul_f32 v28, v28, v204
v_mfma_f32_16x16x32_bf16 v[228:231], a[76:79], a[60:63], v[228:231]
v_mul_f32 v29, v29, v205
v_mul_f32 v30, v30, v206
v_mfma_f32_16x16x32_bf16 v[228:231], a[72:75], a[56:59], v[228:231]
s_waitcnt lgkmcnt(3)
s_waitcnt lgkmcnt(1)
buffer_store_dwordx4 v[36:39], v15, s[20:23], s101 offen offset:128 sc1
v_mul_f32 v31, v31, v207
v_cvt_pk_bf16_f32 v24, v24, v25
v_cvt_pk_bf16_f32 v25, v26, v27
v_mfma_f32_16x16x32_bf16 a[216:219], a[64:67], a[0:3], a[216:219]
ds_read_b64_tr_b16 a[72:73], v4 offset:16896
v_cvt_pk_bf16_f32 v26, v28, v29
v_mfma_f32_16x16x32_bf16 a[216:219], a[68:71], a[4:7], a[216:219]
v_cvt_pk_bf16_f32 v27, v30, v31
v_mul_f32 v16, v16, v176
v_mfma_f32_16x16x32_bf16 v[28:31], a[212:215], a[156:159], 0
ds_write_b128 v10, v[24:27] offset:4096
v_mfma_f32_16x16x32_bf16 v[24:27], a[208:211], a[156:159], 0
v_mul_f32 v17, v17, v177
v_mul_f32 v18, v18, v178
v_mfma_f32_16x16x32_bf16 a[220:223], a[68:71], a[12:15], a[220:223]
ds_read_b64_tr_b16 a[74:75], v4 offset:20992
v_mul_f32 v19, v19, v179
v_mfma_f32_16x16x32_bf16 a[220:223], a[64:67], a[8:11], a[220:223]
v_mul_f32 v20, v20, v208
v_mul_f32 v21, v21, v209
v_mfma_f32_16x16x32_bf16 v[232:235], a[64:67], a[16:19], v[232:235]
ds_read_b64_tr_b16 a[76:77], v4 offset:25088
v_mul_f32 v22, v22, v210
v_mfma_f32_16x16x32_bf16 v[232:235], a[68:71], a[20:23], v[232:235]
s_sub_u32 s72, s36, s37
v_add_u32 v9, s72, v9
v_mul_f32 v23, v23, v211
v_mfma_f32_16x16x32_bf16 v[236:239], a[68:71], a[28:31], v[236:239]
s_waitcnt lgkmcnt(2)
s_barrier
ds_read_b64_tr_b16 a[78:79], v4 offset:29184
v_mfma_f32_16x16x32_bf16 v[236:239], a[64:67], a[24:27], v[236:239]
ds_read_b64 v[36:37], v9 offset:0
v_cvt_pk_bf16_f32 v16, v16, v17
v_mfma_f32_16x16x32_bf16 v[240:243], a[64:67], a[32:35], v[240:243]
v_add_u32 v3, s4, v3
v_add_u32 v4, s4, v4
v_mfma_f32_16x16x32_bf16 v[240:243], a[68:71], a[36:39], v[240:243]
ds_read_b64 v[38:39], v9 offset:256
v_cvt_pk_bf16_f32 v17, v18, v19
v_mfma_f32_16x16x32_bf16 v[244:247], a[68:71], a[44:47], v[244:247]
v_cvt_pk_bf16_f32 v18, v20, v21
v_cvt_pk_bf16_f32 v19, v22, v23
v_mfma_f32_16x16x32_bf16 v[20:23], a[212:215], a[160:163], 0
ds_write_b128 v10, v[16:19] offset:8192
v_mfma_f32_16x16x32_bf16 v[16:19], a[208:211], a[160:163], 0
v_mul_f32 v24, v24, v180
v_mul_f32 v25, v25, v181
v_mfma_f32_16x16x32_bf16 v[244:247], a[64:67], a[40:43], v[244:247]
v_mul_f32 v26, v26, v182
v_mul_f32 v27, v27, v183
v_mfma_f32_16x16x32_bf16 v[248:251], a[64:67], a[48:51], v[248:251]
v_mul_f32 v28, v28, v212
v_mul_f32 v29, v29, v213
v_mfma_f32_16x16x32_bf16 v[248:251], a[68:71], a[52:55], v[248:251]
v_mul_f32 v30, v30, v214
v_mul_f32 v31, v31, v215
v_mfma_f32_16x16x32_bf16 v[252:255], a[68:71], a[60:63], v[252:255]
v_cvt_pk_bf16_f32 v24, v24, v25
v_cvt_pk_bf16_f32 v25, v26, v27
v_mfma_f32_16x16x32_bf16 v[252:255], a[64:67], a[56:59], v[252:255]
s_waitcnt lgkmcnt(3)
v_mfma_f32_16x16x32_bf16 a[224:227], a[72:75], a[0:3], a[224:227]
s_nop 0
ds_read_b128 a[0:3], v1 offset:0
ds_read_b64_tr_b16 a[64:65], v3 offset:16896
v_mfma_f32_16x16x32_bf16 a[224:227], a[76:79], a[4:7], a[224:227]
s_waitcnt lgkmcnt(3)
buffer_store_dwordx4 v[36:39], v15, s[20:23], 0 offen offset:256 sc1
ds_read_b128 a[4:7], v2 offset:0
v_cvt_pk_bf16_f32 v26, v28, v29
v_cvt_pk_bf16_f32 v27, v30, v31
v_mfma_f32_16x16x32_bf16 v[28:31], a[212:215], a[164:167], 0
ds_write_b128 v10, v[24:27] offset:12288
v_mfma_f32_16x16x32_bf16 v[24:27], a[208:211], a[164:167], 0
v_mul_f32 v16, v16, v184
v_mul_f32 v17, v17, v185
v_mfma_f32_16x16x32_bf16 a[228:231], a[76:79], a[12:15], a[228:231]
s_nop 0
ds_read_b128 a[12:15], v2 offset:2048
ds_read_b64_tr_b16 a[66:67], v3 offset:20992
v_mfma_f32_16x16x32_bf16 a[228:231], a[72:75], a[8:11], a[228:231]
s_nop 0
ds_read_b128 a[8:11], v1 offset:2048
ds_read_b64 v[36:37], v9 offset:4096
v_mfma_f32_16x16x32_bf16 a[232:235], a[72:75], a[16:19], a[232:235]
s_nop 0
ds_read_b128 a[16:19], v1 offset:4096
ds_read_b64_tr_b16 a[68:69], v3 offset:25088
v_mfma_f32_16x16x32_bf16 a[232:235], a[76:79], a[20:23], a[232:235]
s_nop 0
ds_read_b128 a[20:23], v2 offset:4096
ds_read_b64 v[38:39], v9 offset:4352
v_mfma_f32_16x16x32_bf16 a[236:239], a[76:79], a[28:31], a[236:239]
s_nop 0
ds_read_b128 a[28:31], v2 offset:6144
ds_read_b64_tr_b16 a[70:71], v3 offset:29184
v_mfma_f32_16x16x32_bf16 a[236:239], a[72:75], a[24:27], a[236:239]
ds_read_b128 a[24:27], v1 offset:6144
v_mul_f32 v18, v18, v186
v_mfma_f32_16x16x32_bf16 a[240:243], a[72:75], a[32:35], a[240:243]
ds_read_b128 a[32:35], v1 offset:8192
v_mul_f32 v19, v19, v187
v_mfma_f32_16x16x32_bf16 a[240:243], a[76:79], a[36:39], a[240:243]
ds_read_b128 a[36:39], v2 offset:8192
v_mul_f32 v20, v20, v216
v_mfma_f32_16x16x32_bf16 a[244:247], a[76:79], a[44:47], a[244:247]
ds_read_b128 a[44:47], v2 offset:10240
v_mul_f32 v21, v21, v217
v_mfma_f32_16x16x32_bf16 a[244:247], a[72:75], a[40:43], a[244:247]
ds_read_b128 a[40:43], v1 offset:10240
v_mul_f32 v22, v22, v218
v_mfma_f32_16x16x32_bf16 a[248:251], a[72:75], a[48:51], a[248:251]
ds_read_b128 a[48:51], v1 offset:12288
v_mul_f32 v23, v23, v219
v_mfma_f32_16x16x32_bf16 a[248:251], a[76:79], a[52:55], a[248:251]
s_waitcnt lgkmcnt(8)
buffer_store_dwordx4 v[36:39], v15, s[20:23], s33 offen offset:2304 sc1
ds_read_b128 a[52:55], v2 offset:12288
v_cvt_pk_bf16_f32 v16, v16, v17
v_cvt_pk_bf16_f32 v17, v18, v19
v_mfma_f32_16x16x32_bf16 a[252:255], a[76:79], a[60:63], a[252:255]
s_barrier
ds_read_b128 a[60:63], v2 offset:14336
v_mfma_f32_16x16x32_bf16 a[252:255], a[72:75], a[56:59], a[252:255]
s_waitcnt lgkmcnt(8)
ds_read_b128 a[56:59], v1 offset:14336
ds_read_b64 v[36:37], v9 offset:8192
v_mfma_f32_16x16x32_bf16 a[216:219], a[64:67], a[0:3], a[216:219]
s_nop 0
ds_read_b64_tr_b16 a[72:73], v4 offset:16896
ds_read_b64 v[38:39], v9 offset:8448
v_mfma_f32_16x16x32_bf16 a[216:219], a[68:71], a[4:7], a[216:219]
v_cvt_pk_bf16_f32 v18, v20, v21
v_cvt_pk_bf16_f32 v19, v22, v23
v_mfma_f32_16x16x32_bf16 v[20:23], a[212:215], a[168:171], 0
ds_write_b128 v10, v[16:19] offset:16384
v_mfma_f32_16x16x32_bf16 v[16:19], a[208:211], a[168:171], 0
v_mul_f32 v24, v24, v188
v_mul_f32 v25, v25, v189
v_mfma_f32_16x16x32_bf16 a[220:223], a[68:71], a[12:15], a[220:223]
ds_read_b64_tr_b16 a[74:75], v4 offset:20992
v_mul_f32 v26, v26, v190
v_mfma_f32_16x16x32_bf16 a[220:223], a[64:67], a[8:11], a[220:223]
s_waitcnt lgkmcnt(13)
v_mul_f32 v27, v27, v191
v_mul_f32 v28, v28, v220
v_mfma_f32_16x16x32_bf16 v[232:235], a[64:67], a[16:19], v[232:235]
ds_read_b64_tr_b16 a[76:77], v4 offset:25088
v_mul_f32 v29, v29, v221
v_mfma_f32_16x16x32_bf16 v[232:235], a[68:71], a[20:23], v[232:235]
v_mul_f32 v30, v30, v222
v_mul_f32 v31, v31, v223
v_mfma_f32_16x16x32_bf16 v[236:239], a[68:71], a[28:31], v[236:239]
ds_read_b64_tr_b16 a[78:79], v4 offset:29184
v_cvt_pk_bf16_f32 v24, v24, v25
v_mfma_f32_16x16x32_bf16 v[236:239], a[64:67], a[24:27], v[236:239]
s_waitcnt lgkmcnt(11)
v_cvt_pk_bf16_f32 v25, v26, v27
v_cvt_pk_bf16_f32 v26, v28, v29
v_mfma_f32_16x16x32_bf16 v[240:243], a[64:67], a[32:35], v[240:243]
s_waitcnt lgkmcnt(4)
buffer_store_dwordx4 v[36:39], v15, s[20:23], s34 offen offset:256 sc1
v_cvt_pk_bf16_f32 v27, v30, v31
v_mul_f32 v16, v16, v192
v_mul_f32 v17, v17, v193
v_mfma_f32_16x16x32_bf16 v[28:31], a[212:215], a[172:175], 0
ds_write_b128 v10, v[24:27] offset:20480
v_mfma_f32_16x16x32_bf16 v[24:27], a[208:211], a[172:175], 0
v_mul_f32 v18, v18, v194
v_mul_f32 v19, v19, v195
v_mfma_f32_16x16x32_bf16 v[240:243], a[68:71], a[36:39], v[240:243]
v_mul_f32 v20, v20, v224
v_mul_f32 v21, v21, v225
v_mfma_f32_16x16x32_bf16 v[244:247], a[68:71], a[44:47], v[244:247]
ds_read_b64 v[36:37], v9 offset:12288
v_mul_f32 v22, v22, v226
v_mfma_f32_16x16x32_bf16 v[244:247], a[64:67], a[40:43], v[244:247]
ds_read_b64 v[38:39], v9 offset:12544
v_mul_f32 v23, v23, v227
v_mfma_f32_16x16x32_bf16 v[248:251], a[64:67], a[48:51], v[248:251]
v_cvt_pk_bf16_f32 v16, v16, v17
v_cvt_pk_bf16_f32 v17, v18, v19
v_mfma_f32_16x16x32_bf16 v[248:251], a[68:71], a[52:55], v[248:251]
v_cvt_pk_bf16_f32 v18, v20, v21
v_cvt_pk_bf16_f32 v19, v22, v23
v_mfma_f32_16x16x32_bf16 v[20:23], a[212:215], a[176:179], 0
ds_write_b128 v10, v[16:19] offset:24576
v_mfma_f32_16x16x32_bf16 v[16:19], a[208:211], a[176:179], 0
v_mul_f32 v24, v24, v196
v_mul_f32 v25, v25, v197
v_mfma_f32_16x16x32_bf16 v[252:255], a[68:71], a[60:63], v[252:255]
v_mul_f32 v26, v26, v198
v_mul_f32 v27, v27, v199
v_mfma_f32_16x16x32_bf16 v[252:255], a[64:67], a[56:59], v[252:255]
s_waitcnt lgkmcnt(4)
v_mfma_f32_16x16x32_bf16 a[224:227], a[72:75], a[0:3], a[224:227]
v_mul_f32 v28, v28, v228
v_mul_f32 v29, v29, v229
v_mfma_f32_16x16x32_bf16 a[224:227], a[76:79], a[4:7], a[224:227]
v_mul_f32 v30, v30, v230
v_mul_f32 v31, v31, v231
v_mfma_f32_16x16x32_bf16 a[228:231], a[76:79], a[12:15], a[228:231]
v_cvt_pk_bf16_f32 v24, v24, v25
v_cvt_pk_bf16_f32 v25, v26, v27
v_mfma_f32_16x16x32_bf16 a[228:231], a[72:75], a[8:11], a[228:231]
s_waitcnt lgkmcnt(1)
buffer_store_dwordx4 v[36:39], v15, s[20:23], s35 offen offset:2304 sc1
v_cvt_pk_bf16_f32 v26, v28, v29
v_cvt_pk_bf16_f32 v27, v30, v31
v_mfma_f32_16x16x32_bf16 v[28:31], a[212:215], a[180:183], 0
ds_write_b128 v10, v[24:27] offset:28672
v_mfma_f32_16x16x32_bf16 v[24:27], a[208:211], a[180:183], 0
v_mfma_f32_16x16x32_bf16 a[232:235], a[72:75], a[16:19], a[232:235]
s_waitcnt lgkmcnt(1)
s_barrier
v_mfma_f32_16x16x32_bf16 a[232:235], a[76:79], a[20:23], a[232:235]
ds_read_b64 v[36:37], v9 offset:16384
v_mfma_f32_16x16x32_bf16 a[236:239], a[76:79], a[28:31], a[236:239]
ds_read_b64 v[38:39], v9 offset:16640
v_mfma_f32_16x16x32_bf16 a[236:239], a[72:75], a[24:27], a[236:239]
v_mfma_f32_16x16x32_bf16 a[240:243], a[72:75], a[32:35], a[240:243]
v_mfma_f32_16x16x32_bf16 a[240:243], a[76:79], a[36:39], a[240:243]
v_mfma_f32_16x16x32_bf16 a[244:247], a[76:79], a[44:47], a[244:247]
v_mfma_f32_16x16x32_bf16 a[244:247], a[72:75], a[40:43], a[244:247]
v_mfma_f32_16x16x32_bf16 a[248:251], a[72:75], a[48:51], a[248:251]
v_mfma_f32_16x16x32_bf16 a[248:251], a[76:79], a[52:55], a[248:251]
v_mfma_f32_16x16x32_bf16 a[252:255], a[76:79], a[60:63], a[252:255]
s_waitcnt lgkmcnt(0)
buffer_store_dwordx4 v[36:39], v15, s[20:23], s62 offen offset:256 sc1
v_mfma_f32_16x16x32_bf16 a[252:255], a[72:75], a[56:59], a[252:255]
ds_read_b64 v[36:37], v9 offset:20480
ds_read_b64 v[38:39], v9 offset:20736
s_waitcnt lgkmcnt(0)
buffer_store_dwordx4 v[36:39], v15, s[20:23], s63 offen offset:256 sc1
s_nop 7
v_lshlrev_b32 v5, 16, v7
v_and_b32 v7, s65, v7
v_lshlrev_b32 v6, 16, v8
v_and_b32 v8, s65, v8
s_barrier
ds_read_b64 a[48:49], v9 offset:24576
ds_read_b64 a[50:51], v9 offset:24832
ds_read_b64 a[56:57], v9 offset:28672
ds_read_b64 a[58:59], v9 offset:28928
s_sub_u32 s73, s37, s36
v_add_u32 v10, s73, v10
v_accvgpr_read_b32 v32, a224
v_accvgpr_read_b32 v33, a225
v_accvgpr_read_b32 v34, a226
v_accvgpr_read_b32 v35, a227
v_add_f32 v32, v32, v5
v_add_f32 v33, v33, v7
v_add_f32 v34, v34, v6
v_add_f32 v35, v35, v8
v_pk_mul_f32 v[20:21], v[20:21], v[32:33]
v_pk_mul_f32 v[22:23], v[22:23], v[34:35]
v_accvgpr_read_b32 v32, a216
v_accvgpr_read_b32 v33, a217
v_accvgpr_read_b32 v34, a218
v_accvgpr_read_b32 v35, a219
v_pk_mul_f32 v[16:17], v[16:17], v[32:33]
v_pk_mul_f32 v[18:19], v[18:19], v[34:35]
v_cvt_pk_bf16_f32 v16, v16, v17
v_cvt_pk_bf16_f32 v17, v18, v19
v_cvt_pk_bf16_f32 v18, v20, v21
v_cvt_pk_bf16_f32 v19, v22, v23
v_mfma_f32_16x16x32_bf16 v[20:23], a[212:215], a[184:187], 0
ds_write_b128 v10, v[16:19] offset:0
v_mfma_f32_16x16x32_bf16 v[16:19], a[208:211], a[184:187], 0
s_waitcnt lgkmcnt(3)
buffer_store_dwordx4 a[48:51], v15, s[20:23], s64 offen offset:256 sc1
v_accvgpr_read_b32 v32, a228
v_accvgpr_read_b32 v33, a229
v_accvgpr_read_b32 v34, a230
v_accvgpr_read_b32 v35, a231
v_add_f32 v32, v32, v5
v_add_f32 v33, v33, v7
v_add_f32 v34, v34, v6
v_add_f32 v35, v35, v8
v_pk_mul_f32 v[28:29], v[28:29], v[32:33]
v_pk_mul_f32 v[30:31], v[30:31], v[34:35]
v_accvgpr_read_b32 v32, a220
v_accvgpr_read_b32 v33, a221
v_accvgpr_read_b32 v34, a222
v_accvgpr_read_b32 v35, a223
v_pk_mul_f32 v[24:25], v[24:25], v[32:33]
v_pk_mul_f32 v[26:27], v[26:27], v[34:35]
v_cvt_pk_bf16_f32 v24, v24, v25
v_cvt_pk_bf16_f32 v25, v26, v27
v_cvt_pk_bf16_f32 v26, v28, v29
v_cvt_pk_bf16_f32 v27, v30, v31
v_mfma_f32_16x16x32_bf16 v[28:31], a[212:215], a[188:191], 0
ds_write_b128 v10, v[24:27] offset:4096
v_mfma_f32_16x16x32_bf16 v[24:27], a[208:211], a[188:191], 0
s_waitcnt lgkmcnt(2)
buffer_store_dwordx4 a[56:59], v15, s[20:23], s101 offen offset:256 sc1
v_accvgpr_read_b32 v32, a232
v_accvgpr_read_b32 v33, a233
v_accvgpr_read_b32 v34, a234
v_accvgpr_read_b32 v35, a235
v_add_f32 v32, v32, v5
v_add_f32 v33, v33, v7
v_add_f32 v34, v34, v6
v_add_f32 v35, v35, v8
v_pk_mul_f32 v[20:21], v[20:21], v[32:33]
v_pk_mul_f32 v[22:23], v[22:23], v[34:35]
v_pk_mul_f32 v[16:17], v[16:17], v[232:233]
v_pk_mul_f32 v[18:19], v[18:19], v[234:235]
v_cvt_pk_bf16_f32 v16, v16, v17
v_cvt_pk_bf16_f32 v17, v18, v19
v_cvt_pk_bf16_f32 v18, v20, v21
v_cvt_pk_bf16_f32 v19, v22, v23
v_mfma_f32_16x16x32_bf16 v[20:23], a[212:215], a[192:195], 0
ds_write_b128 v10, v[16:19] offset:8192
v_mfma_f32_16x16x32_bf16 v[16:19], a[208:211], a[192:195], 0
s_waitcnt lgkmcnt(0)
s_barrier
s_sub_u32 s72, s37, s36
v_add_u32 v9, s72, v9
ds_read_b64 a[4:5], v9 offset:0
ds_read_b64 a[6:7], v9 offset:256
ds_read_b64 a[12:13], v9 offset:4096
ds_read_b64 a[14:15], v9 offset:4352
ds_read_b64 a[20:21], v9 offset:8192
ds_read_b64 a[22:23], v9 offset:8448
v_accvgpr_read_b32 v32, a236
v_accvgpr_read_b32 v33, a237
v_accvgpr_read_b32 v34, a238
v_accvgpr_read_b32 v35, a239
v_add_f32 v32, v32, v5
v_add_f32 v33, v33, v7
v_add_f32 v34, v34, v6
v_add_f32 v35, v35, v8
v_pk_mul_f32 v[28:29], v[28:29], v[32:33]
v_pk_mul_f32 v[30:31], v[30:31], v[34:35]
v_pk_mul_f32 v[24:25], v[24:25], v[236:237]
v_pk_mul_f32 v[26:27], v[26:27], v[238:239]
v_cvt_pk_bf16_f32 v24, v24, v25
v_cvt_pk_bf16_f32 v25, v26, v27
v_cvt_pk_bf16_f32 v26, v28, v29
v_cvt_pk_bf16_f32 v27, v30, v31
v_mfma_f32_16x16x32_bf16 v[28:31], a[212:215], a[196:199], 0
ds_write_b128 v10, v[24:27] offset:12288
v_mfma_f32_16x16x32_bf16 v[24:27], a[208:211], a[196:199], 0
s_waitcnt lgkmcnt(5)
buffer_store_dwordx4 a[4:7], v15, s[20:23], 0 offen offset:384 sc1
v_accvgpr_read_b32 v32, a240
v_accvgpr_read_b32 v33, a241
v_accvgpr_read_b32 v34, a242
v_accvgpr_read_b32 v35, a243
v_add_f32 v32, v32, v5
v_add_f32 v33, v33, v7
v_add_f32 v34, v34, v6
v_add_f32 v35, v35, v8
v_pk_mul_f32 v[20:21], v[20:21], v[32:33]
v_pk_mul_f32 v[22:23], v[22:23], v[34:35]
v_pk_mul_f32 v[16:17], v[16:17], v[240:241]
v_pk_mul_f32 v[18:19], v[18:19], v[242:243]
v_cvt_pk_bf16_f32 v16, v16, v17
v_cvt_pk_bf16_f32 v17, v18, v19
v_cvt_pk_bf16_f32 v18, v20, v21
v_cvt_pk_bf16_f32 v19, v22, v23
v_mfma_f32_16x16x32_bf16 v[20:23], a[212:215], a[200:203], 0
ds_write_b128 v10, v[16:19] offset:16384
v_mfma_f32_16x16x32_bf16 v[16:19], a[208:211], a[200:203], 0
s_waitcnt lgkmcnt(4)
buffer_store_dwordx4 a[12:15], v15, s[20:23], s33 offen offset:2432 sc1
v_accvgpr_read_b32 v32, a244
v_accvgpr_read_b32 v33, a245
v_accvgpr_read_b32 v34, a246
v_accvgpr_read_b32 v35, a247
v_add_f32 v32, v32, v5
v_add_f32 v33, v33, v7
v_add_f32 v34, v34, v6
v_add_f32 v35, v35, v8
v_pk_mul_f32 v[28:29], v[28:29], v[32:33]
v_pk_mul_f32 v[30:31], v[30:31], v[34:35]
v_pk_mul_f32 v[24:25], v[24:25], v[244:245]
v_pk_mul_f32 v[26:27], v[26:27], v[246:247]
v_cvt_pk_bf16_f32 v24, v24, v25
v_cvt_pk_bf16_f32 v25, v26, v27
v_cvt_pk_bf16_f32 v26, v28, v29
v_cvt_pk_bf16_f32 v27, v30, v31
v_mfma_f32_16x16x32_bf16 v[28:31], a[212:215], a[204:207], 0
ds_write_b128 v10, v[24:27] offset:20480
v_mfma_f32_16x16x32_bf16 v[24:27], a[208:211], a[204:207], 0
s_waitcnt lgkmcnt(3)
buffer_store_dwordx4 a[20:23], v15, s[20:23], s34 offen offset:384 sc1
s_waitcnt lgkmcnt(0)
s_barrier
ds_read_b64 a[28:29], v9 offset:12288
ds_read_b64 a[30:31], v9 offset:12544
ds_read_b64 a[36:37], v9 offset:16384
ds_read_b64 a[38:39], v9 offset:16640
ds_read_b64 a[44:45], v9 offset:20480
ds_read_b64 a[46:47], v9 offset:20736
v_accvgpr_read_b32 v32, a248
v_accvgpr_read_b32 v33, a249
v_accvgpr_read_b32 v34, a250
v_accvgpr_read_b32 v35, a251
v_add_f32 v32, v32, v5
v_add_f32 v33, v33, v7
v_add_f32 v34, v34, v6
v_add_f32 v35, v35, v8
v_pk_mul_f32 v[20:21], v[20:21], v[32:33]
v_pk_mul_f32 v[22:23], v[22:23], v[34:35]
v_pk_mul_f32 v[16:17], v[16:17], v[248:249]
v_pk_mul_f32 v[18:19], v[18:19], v[250:251]
v_cvt_pk_bf16_f32 v16, v16, v17
v_cvt_pk_bf16_f32 v17, v18, v19
v_cvt_pk_bf16_f32 v18, v20, v21
v_cvt_pk_bf16_f32 v19, v22, v23
ds_write_b128 v10, v[16:19] offset:24576
s_waitcnt lgkmcnt(5)
buffer_store_dwordx4 a[28:31], v15, s[20:23], s35 offen offset:2432 sc1
v_accvgpr_read_b32 v32, a252
v_accvgpr_read_b32 v33, a253
v_accvgpr_read_b32 v34, a254
v_accvgpr_read_b32 v35, a255
v_add_f32 v32, v32, v5
v_add_f32 v33, v33, v7
v_add_f32 v34, v34, v6
v_add_f32 v35, v35, v8
v_pk_mul_f32 v[28:29], v[28:29], v[32:33]
v_pk_mul_f32 v[30:31], v[30:31], v[34:35]
v_pk_mul_f32 v[24:25], v[24:25], v[252:253]
v_pk_mul_f32 v[26:27], v[26:27], v[254:255]
v_cvt_pk_bf16_f32 v24, v24, v25
v_cvt_pk_bf16_f32 v25, v26, v27
v_cvt_pk_bf16_f32 v26, v28, v29
v_cvt_pk_bf16_f32 v27, v30, v31
ds_write_b128 v10, v[24:27] offset:28672
s_waitcnt lgkmcnt(4)
buffer_store_dwordx4 a[36:39], v15, s[20:23], s62 offen offset:384 sc1
s_waitcnt lgkmcnt(0)
s_barrier
ds_read_b64 a[52:53], v9 offset:24576
ds_read_b64 a[54:55], v9 offset:24832
ds_read_b64 a[60:61], v9 offset:28672
ds_read_b64 a[62:63], v9 offset:28928
buffer_store_dwordx4 a[44:47], v15, s[20:23], s63 offen offset:384 sc1
s_waitcnt lgkmcnt(2)
buffer_store_dwordx4 a[52:55], v15, s[20:23], s64 offen offset:384 sc1
s_waitcnt lgkmcnt(0)
buffer_store_dwordx4 a[60:63], v15, s[20:23], s101 offen offset:384 sc1
s_or_b32 s70, s54, s55
s_cmp_lg_u32 s70, 0
s_cbranch_scc1 L_fin
s_add_u32 s70, s49, 16
v_mov_b32 v11, s70
buffer_store_dword v11, off, s[16:19], s66 sc1
L_fin:
s_endpgm
CAP_E0:
HOP9:
s_cbranch_execz HOP13
v_mfma_f32_16x16x32_bf16 v[228:231], a[72:75], a[56:59], v[228:231]
s_waitcnt lgkmcnt(0)
ds_read_b128 a[80:83], v36 offset:0
v_mfma_f32_16x16x32_bf16 a[216:219], a[64:67], a[0:3], a[216:219]
s_nop 0
ds_read_b64_tr_b16 a[72:73], v4 offset:16896
ds_read_b128 a[84:87], v36 offset:2048
v_mfma_f32_16x16x32_bf16 a[216:219], a[68:71], a[4:7], a[216:219]
ds_read_b128 a[88:91], v36 offset:4096
v_mfma_f32_16x16x32_bf16 a[220:223], a[68:71], a[12:15], a[220:223]
s_nop 0
ds_read_b64_tr_b16 a[74:75], v4 offset:20992
ds_read_b128 a[92:95], v36 offset:6144
v_mfma_f32_16x16x32_bf16 a[220:223], a[64:67], a[8:11], a[220:223]
ds_read_b128 a[96:99], v36 offset:8192
v_mfma_f32_16x16x32_bf16 v[232:235], a[64:67], a[16:19], v[252:255]
s_nop 0
ds_read_b64_tr_b16 a[76:77], v4 offset:25088
ds_read_b128 a[100:103], v36 offset:10240
v_mfma_f32_16x16x32_bf16 v[232:235], a[68:71], a[20:23], v[232:235]
ds_read_b128 a[104:107], v36 offset:12288
v_mfma_f32_16x16x32_bf16 v[236:239], a[68:71], a[28:31], v[252:255]
s_nop 0
ds_read_b64_tr_b16 a[78:79], v4 offset:29184
ds_read_b128 a[108:111], v36 offset:14336
v_mfma_f32_16x16x32_bf16 v[236:239], a[64:67], a[24:27], v[236:239]
s_branch CB_E0
CAP_G00:
HOP10:
s_cbranch_execz HOP14
v_mfma_f32_16x16x32_bf16 v[204:207], a[76:79], a[12:15], v[204:207]
ds_read_b64_tr_b16 a[66:67], v3 offset:20992
v_mfma_f32_16x16x32_bf16 v[204:207], a[72:75], a[8:11], v[204:207]
v_mfma_f32_16x16x32_bf16 v[208:211], a[72:75], a[16:19], v[208:211]
ds_read_b64_tr_b16 a[68:69], v3 offset:25088
v_mfma_f32_16x16x32_bf16 v[208:211], a[76:79], a[20:23], v[208:211]
v_mfma_f32_16x16x32_bf16 v[212:215], a[76:79], a[28:31], v[212:215]
ds_read_b64_tr_b16 a[70:71], v3 offset:29184
v_mfma_f32_16x16x32_bf16 v[212:215], a[72:75], a[24:27], v[212:215]
v_mfma_f32_16x16x32_bf16 v[216:219], a[72:75], a[32:35], v[216:219]
s_add_u32 m0, s38, 0x1000
v_mfma_f32_16x16x32_bf16 v[216:219], a[76:79], a[36:39], v[216:219]
buffer_load_dwordx4 v7, s[12:15], s34 offen nt lds
v_mfma_f32_16x16x32_bf16 v[220:223], a[76:79], a[44:47], v[220:223]
s_mov_b32 s5, s36
s_mov_b32 s36, s37
s_mov_b32 s37, s38
v_mfma_f32_16x16x32_bf16 v[220:223], a[72:75], a[40:43], v[220:223]
s_mov_b32 s38, s5
s_mov_b32 s5, s39
s_mov_b32 s39, s40
v_mfma_f32_16x16x32_bf16 v[224:227], a[72:75], a[48:51], v[224:227]
s_mov_b32 s40, s5
v_mfma_f32_16x16x32_bf16 v[224:227], a[76:79], a[52:55], v[224:227]
buffer_load_dwordx4 v8, s[12:15], s34 offen offset:1024 nt lds
v_mfma_f32_16x16x32_bf16 v[228:231], a[76:79], a[60:63], v[228:231]
v_mfma_f32_16x16x32_bf16 v[228:231], a[72:75], a[56:59], v[228:231]
s_waitcnt lgkmcnt(0)
ds_read_b128 a[80:83], v36 offset:0
v_mfma_f32_16x16x32_bf16 a[216:219], a[64:67], a[0:3], a[216:219]
s_nop 0
ds_read_b64_tr_b16 a[72:73], v4 offset:16896
ds_read_b128 a[84:87], v36 offset:2048
v_mfma_f32_16x16x32_bf16 a[216:219], a[68:71], a[4:7], a[216:219]
ds_read_b128 a[88:91], v36 offset:4096
v_mfma_f32_16x16x32_bf16 a[220:223], a[68:71], a[12:15], a[220:223]
s_nop 0
ds_read_b64_tr_b16 a[74:75], v4 offset:20992
ds_read_b128 a[92:95], v36 offset:6144
v_mfma_f32_16x16x32_bf16 a[220:223], a[64:67], a[8:11], a[220:223]
ds_read_b128 a[96:99], v36 offset:8192
v_mfma_f32_16x16x32_bf16 v[232:235], a[64:67], a[16:19], v[232:235]
s_nop 0
ds_read_b64_tr_b16 a[76:77], v4 offset:25088
ds_read_b128 a[100:103], v36 offset:10240
v_mfma_f32_16x16x32_bf16 v[232:235], a[68:71], a[20:23], v[232:235]
buffer_load_dwordx4 v7, s[12:15], s35 offen offset:2048 nt lds
v_mfma_f32_16x16x32_bf16 v[236:239], a[68:71], a[28:31], v[236:239]
s_nop 0
ds_read_b64_tr_b16 a[78:79], v4 offset:29184
ds_read_b128 a[104:107], v36 offset:12288
v_mfma_f32_16x16x32_bf16 v[236:239], a[64:67], a[24:27], v[236:239]
ds_read_b128 a[108:111], v36 offset:14336
v_mfma_f32_16x16x32_bf16 v[240:243], a[64:67], a[32:35], v[240:243]
s_branch CB_G0
CAP_G01:
HOP11:
s_cbranch_execz HOP15
v_mfma_f32_16x16x32_bf16 v[208:211], a[72:75], a[16:19], v[208:211]
ds_read_b64_tr_b16 a[68:69], v3 offset:25088
v_mfma_f32_16x16x32_bf16 v[208:211], a[76:79], a[20:23], v[208:211]
v_mfma_f32_16x16x32_bf16 v[212:215], a[76:79], a[28:31], v[212:215]
ds_read_b64_tr_b16 a[70:71], v3 offset:29184
v_mfma_f32_16x16x32_bf16 v[212:215], a[72:75], a[24:27], v[212:215]
v_mfma_f32_16x16x32_bf16 v[216:219], a[72:75], a[32:35], v[216:219]
s_add_u32 m0, s38, 0x1000
v_mfma_f32_16x16x32_bf16 v[216:219], a[76:79], a[36:39], v[216:219]
buffer_load_dwordx4 v7, s[12:15], s34 offen nt lds
v_mfma_f32_16x16x32_bf16 v[220:223], a[76:79], a[44:47], v[220:223]
s_mov_b32 s5, s36
s_mov_b32 s36, s37
s_mov_b32 s37, s38
v_mfma_f32_16x16x32_bf16 v[220:223], a[72:75], a[40:43], v[220:223]
s_mov_b32 s38, s5
s_mov_b32 s5, s39
s_mov_b32 s39, s40
v_mfma_f32_16x16x32_bf16 v[224:227], a[72:75], a[48:51], v[224:227]
s_mov_b32 s40, s5
v_mfma_f32_16x16x32_bf16 v[224:227], a[76:79], a[52:55], v[224:227]
buffer_load_dwordx4 v8, s[12:15], s34 offen offset:1024 nt lds
v_mfma_f32_16x16x32_bf16 v[228:231], a[76:79], a[60:63], v[228:231]
v_mfma_f32_16x16x32_bf16 v[228:231], a[72:75], a[56:59], v[228:231]
s_waitcnt lgkmcnt(0)
ds_read_b128 a[112:115], v36 offset:0
v_mfma_f32_16x16x32_bf16 a[216:219], a[64:67], a[0:3], a[216:219]
s_nop 0
ds_read_b64_tr_b16 a[72:73], v4 offset:16896
ds_read_b128 a[116:119], v36 offset:2048
v_mfma_f32_16x16x32_bf16 a[216:219], a[68:71], a[4:7], a[216:219]
ds_read_b128 a[120:123], v36 offset:4096
v_mfma_f32_16x16x32_bf16 a[220:223], a[68:71], a[12:15], a[220:223]
s_nop 0
ds_read_b64_tr_b16 a[74:75], v4 offset:20992
ds_read_b128 a[124:127], v36 offset:6144
v_mfma_f32_16x16x32_bf16 a[220:223], a[64:67], a[8:11], a[220:223]
ds_read_b128 a[128:131], v36 offset:8192
v_mfma_f32_16x16x32_bf16 v[232:235], a[64:67], a[16:19], v[232:235]
s_nop 0
ds_read_b64_tr_b16 a[76:77], v4 offset:25088
ds_read_b128 a[132:135], v36 offset:10240
v_mfma_f32_16x16x32_bf16 v[232:235], a[68:71], a[20:23], v[232:235]
buffer_load_dwordx4 v7, s[12:15], s35 offen offset:2048 nt lds
v_mfma_f32_16x16x32_bf16 v[236:239], a[68:71], a[28:31], v[236:239]
s_nop 0
ds_read_b64_tr_b16 a[78:79], v4 offset:29184
ds_read_b128 a[136:139], v36 offset:12288
v_mfma_f32_16x16x32_bf16 v[236:239], a[64:67], a[24:27], v[236:239]
ds_read_b128 a[140:143], v36 offset:14336
v_mfma_f32_16x16x32_bf16 v[240:243], a[64:67], a[32:35], v[240:243]
s_branch CB_G0
CAP_G02:
HOP12:
s_cbranch_execz HOPEND
v_mfma_f32_16x16x32_bf16 v[212:215], a[76:79], a[28:31], v[212:215]
ds_read_b64_tr_b16 a[70:71], v3 offset:29184
v_mfma_f32_16x16x32_bf16 v[212:215], a[72:75], a[24:27], v[212:215]
v_mfma_f32_16x16x32_bf16 v[216:219], a[72:75], a[32:35], v[216:219]
s_add_u32 m0, s38, 0x1000
v_mfma_f32_16x16x32_bf16 v[216:219], a[76:79], a[36:39], v[216:219]
buffer_load_dwordx4 v7, s[12:15], s34 offen nt lds
v_mfma_f32_16x16x32_bf16 v[220:223], a[76:79], a[44:47], v[220:223]
s_mov_b32 s5, s36
s_mov_b32 s36, s37
s_mov_b32 s37, s38
v_mfma_f32_16x16x32_bf16 v[220:223], a[72:75], a[40:43], v[220:223]
s_mov_b32 s38, s5
s_mov_b32 s5, s39
s_mov_b32 s39, s40
v_mfma_f32_16x16x32_bf16 v[224:227], a[72:75], a[48:51], v[224:227]
s_mov_b32 s40, s5
v_mfma_f32_16x16x32_bf16 v[224:227], a[76:79], a[52:55], v[224:227]
buffer_load_dwordx4 v8, s[12:15], s34 offen offset:1024 nt lds
v_mfma_f32_16x16x32_bf16 v[228:231], a[76:79], a[60:63], v[228:231]
v_mfma_f32_16x16x32_bf16 v[228:231], a[72:75], a[56:59], v[228:231]
s_waitcnt lgkmcnt(0)
ds_read_b128 a[144:147], v36 offset:0
v_mfma_f32_16x16x32_bf16 a[216:219], a[64:67], a[0:3], a[216:219]
s_nop 0
ds_read_b64_tr_b16 a[72:73], v4 offset:16896
ds_read_b128 a[148:151], v36 offset:2048
v_mfma_f32_16x16x32_bf16 a[216:219], a[68:71], a[4:7], a[216:219]
ds_read_b128 a[152:155], v36 offset:4096
v_mfma_f32_16x16x32_bf16 a[220:223], a[68:71], a[12:15], a[220:223]
s_nop 0
ds_read_b64_tr_b16 a[74:75], v4 offset:20992
ds_read_b128 a[156:159], v36 offset:6144
v_mfma_f32_16x16x32_bf16 a[220:223], a[64:67], a[8:11], a[220:223]
ds_read_b128 a[160:163], v36 offset:8192
v_mfma_f32_16x16x32_bf16 v[232:235], a[64:67], a[16:19], v[232:235]
s_nop 0
ds_read_b64_tr_b16 a[76:77], v4 offset:25088
ds_read_b128 a[164:167], v36 offset:10240
v_mfma_f32_16x16x32_bf16 v[232:235], a[68:71], a[20:23], v[232:235]
buffer_load_dwordx4 v7, s[12:15], s35 offen offset:2048 nt lds
v_mfma_f32_16x16x32_bf16 v[236:239], a[68:71], a[28:31], v[236:239]
s_nop 0
ds_read_b64_tr_b16 a[78:79], v4 offset:29184
ds_read_b128 a[168:171], v36 offset:12288
v_mfma_f32_16x16x32_bf16 v[236:239], a[64:67], a[24:27], v[236:239]
ds_read_b128 a[172:175], v36 offset:14336
v_mfma_f32_16x16x32_bf16 v[240:243], a[64:67], a[32:35], v[240:243]
s_branch CB_G0
CAP_G03:
HOP13:
s_cbranch_execz HOPEND
v_mfma_f32_16x16x32_bf16 v[216:219], a[72:75], a[32:35], v[216:219]
s_add_u32 m0, s38, 0x1000
v_mfma_f32_16x16x32_bf16 v[216:219], a[76:79], a[36:39], v[216:219]
buffer_load_dwordx4 v7, s[12:15], s34 offen nt lds
v_mfma_f32_16x16x32_bf16 v[220:223], a[76:79], a[44:47], v[220:223]
s_mov_b32 s5, s36
s_mov_b32 s36, s37
s_mov_b32 s37, s38
v_mfma_f32_16x16x32_bf16 v[220:223], a[72:75], a[40:43], v[220:223]
s_mov_b32 s38, s5
s_mov_b32 s5, s39
s_mov_b32 s39, s40
v_mfma_f32_16x16x32_bf16 v[224:227], a[72:75], a[48:51], v[224:227]
s_mov_b32 s40, s5
v_mfma_f32_16x16x32_bf16 v[224:227], a[76:79], a[52:55], v[224:227]
buffer_load_dwordx4 v8, s[12:15], s34 offen offset:1024 nt lds
v_mfma_f32_16x16x32_bf16 v[228:231], a[76:79], a[60:63], v[228:231]
v_mfma_f32_16x16x32_bf16 v[228:231], a[72:75], a[56:59], v[228:231]
s_waitcnt lgkmcnt(0)
ds_read_b128 a[176:179], v36 offset:0
v_mfma_f32_16x16x32_bf16 a[216:219], a[64:67], a[0:3], a[216:219]
s_nop 0
ds_read_b64_tr_b16 a[72:73], v4 offset:16896
ds_read_b128 a[180:183], v36 offset:2048
v_mfma_f32_16x16x32_bf16 a[216:219], a[68:71], a[4:7], a[216:219]
ds_read_b128 a[184:187], v36 offset:4096
v_mfma_f32_16x16x32_bf16 a[220:223], a[68:71], a[12:15], a[220:223]
s_nop 0
ds_read_b64_tr_b16 a[74:75], v4 offset:20992
ds_read_b128 a[188:191], v36 offset:6144
v_mfma_f32_16x16x32_bf16 a[220:223], a[64:67], a[8:11], a[220:223]
ds_read_b128 a[192:195], v36 offset:8192
v_mfma_f32_16x16x32_bf16 v[232:235], a[64:67], a[16:19], v[232:235]
s_nop 0
ds_read_b64_tr_b16 a[76:77], v4 offset:25088
ds_read_b128 a[196:199], v36 offset:10240
v_mfma_f32_16x16x32_bf16 v[232:235], a[68:71], a[20:23], v[232:235]
buffer_load_dwordx4 v7, s[12:15], s35 offen offset:2048 nt lds
v_mfma_f32_16x16x32_bf16 v[236:239], a[68:71], a[28:31], v[236:239]
s_nop 0
ds_read_b64_tr_b16 a[78:79], v4 offset:29184
ds_read_b128 a[200:203], v36 offset:12288
v_mfma_f32_16x16x32_bf16 v[236:239], a[64:67], a[24:27], v[236:239]
ds_read_b128 a[204:207], v36 offset:14336
v_mfma_f32_16x16x32_bf16 v[240:243], a[64:67], a[32:35], v[240:243]
s_branch CB_G0
CAP_T14:
HOP14:
s_cbranch_execz HOPEND
v_mfma_f32_16x16x32_bf16 v[228:231], a[72:75], a[56:59], v[228:231]
s_waitcnt lgkmcnt(0)
ds_read_b128 a[144:147], v36 offset:0
v_mfma_f32_16x16x32_bf16 a[216:219], a[64:67], a[0:3], a[216:219]
s_nop 0
ds_read_b64_tr_b16 a[72:73], v4 offset:16896
ds_read_b128 a[148:151], v36 offset:2048
v_mfma_f32_16x16x32_bf16 a[216:219], a[68:71], a[4:7], a[216:219]
ds_read_b128 a[152:155], v36 offset:4096
v_mfma_f32_16x16x32_bf16 a[220:223], a[68:71], a[12:15], a[220:223]
s_nop 0
ds_read_b64_tr_b16 a[74:75], v4 offset:20992
ds_read_b128 a[156:159], v36 offset:6144
v_mfma_f32_16x16x32_bf16 a[220:223], a[64:67], a[8:11], a[220:223]
ds_read_b128 a[160:163], v36 offset:8192
v_mfma_f32_16x16x32_bf16 v[232:235], a[64:67], a[16:19], v[232:235]
s_nop 0
ds_read_b64_tr_b16 a[76:77], v4 offset:25088
ds_read_b128 a[164:167], v36 offset:10240
v_mfma_f32_16x16x32_bf16 v[232:235], a[68:71], a[20:23], v[232:235]
ds_read_b128 a[168:171], v36 offset:12288
v_mfma_f32_16x16x32_bf16 v[236:239], a[68:71], a[28:31], v[236:239]
s_nop 0
ds_read_b64_tr_b16 a[78:79], v4 offset:29184
ds_read_b128 a[172:175], v36 offset:14336
v_mfma_f32_16x16x32_bf16 v[236:239], a[64:67], a[24:27], v[236:239]
s_branch CB_T14
CAP_T15:
HOP15:
s_cbranch_execz HOPEND
v_mfma_f32_16x16x32_bf16 v[44:47], a[68:71], a[12:15], v[44:47]
s_sub_u32 s4, s37, s39
ds_read_b64_tr_b16 a[74:75], v4 offset:4096
ds_read_b128 a[176:179], v36 offset:0
v_mfma_f32_16x16x32_bf16 v[44:47], a[64:67], a[8:11], v[44:47]
s_waitcnt lgkmcnt(10)
ds_read_b128 a[180:183], v36 offset:2048
v_mfma_f32_16x16x32_bf16 v[48:51], a[64:67], a[16:19], v[48:51]
s_nop 0
ds_read_b64_tr_b16 a[76:77], v4 offset:8192
ds_read_b128 a[184:187], v36 offset:4096
v_mfma_f32_16x16x32_bf16 v[48:51], a[68:71], a[20:23], v[48:51]
ds_read_b128 a[188:191], v36 offset:6144
v_mfma_f32_16x16x32_bf16 v[52:55], a[68:71], a[28:31], v[52:55]
s_nop 0
ds_read_b64_tr_b16 a[78:79], v4 offset:12288
ds_read_b128 a[192:195], v36 offset:8192
v_mfma_f32_16x16x32_bf16 v[52:55], a[64:67], a[24:27], v[52:55]
s_waitcnt lgkmcnt(8)
ds_read_b128 a[196:199], v36 offset:10240
v_mfma_f32_16x16x32_bf16 v[56:59], a[64:67], a[32:35], v[56:59]
ds_read_b128 a[200:203], v36 offset:12288
v_mfma_f32_16x16x32_bf16 v[56:59], a[68:71], a[36:39], v[56:59]
ds_read_b128 a[204:207], v36 offset:14336
v_mfma_f32_16x16x32_bf16 v[60:63], a[68:71], a[44:47], v[60:63]
s_branch CB_T15
L_codeend:
.section .rodata,"a"
.p2align 6
.amdhsa_kernel standalone__dcn_v2_cross__recsys_kernel
  .amdhsa_next_free_vgpr 512
  .amdhsa_next_free_sgpr 102
  .amdhsa_accum_offset 256
  .amdhsa_group_segment_fixed_size 0
  .amdhsa_kernarg_size 48
  .amdhsa_user_sgpr_count 2
  .amdhsa_user_sgpr_kernarg_segment_ptr 1
  .amdhsa_system_sgpr_workgroup_id_x 1
  .amdhsa_float_denorm_mode_32 3
.end_amdhsa_kernel
```
